```python
import torch

def _softmax(x, axis=-1):
    return torch.softmax(x, dim=axis)
def _gelu(x):
    return torch.nn.functional.gelu(x, approximate="tanh")
def _silu(x):
    return torch.nn.functional.silu(x)
def _sigmoid(x):
    return torch.sigmoid(x)
def _layernorm(x, axis=-1, eps=1e-5):
    m = x.mean(dim=axis, keepdim=True)
    v = x.var(dim=axis, keepdim=True, unbiased=False)
    return (x - m) / torch.sqrt(v + eps)
def _scatter_add(tgt, idx, src, axis=0):
    return tgt.clone().index_add_(axis, idx, src)
def _segment_sum(src, seg, n):
    out = torch.zeros((n,) + src.shape[1:], dtype=src.dtype)
    return out.index_add_(0, seg, src)
def _pad(x, pw):
    flat = tuple(v for pair in reversed(pw) for v in pair)
    return torch.nn.functional.pad(x, flat)

kernel_name = 'standalone__mha_softmax__sampling'

def setup_inputs():

    _w = (lambda a: (lambda t: t.to(torch.bfloat16) if t.is_floating_point() else t)(torch.as_tensor(a)))
    B, H, Sq, Sk, D = 8, 32, 16, 2048, 128
    return {
        "q": _w((lambda *s: torch.randn(*s, dtype=torch.bfloat16) * 0.8)(B, H, Sq, D)),
        "k": _w((lambda *s: torch.randn(*s, dtype=torch.bfloat16) * 0.8)(B, H, Sk, D)),
        "v": _w((lambda *s: torch.randn(*s, dtype=torch.bfloat16) * 0.05)(B, H, Sk, D)),
    }

def reference(q, k, v):
    scale = q.shape[-1] ** -0.5
    scores = torch.einsum("bhqd,bhkd->bhqk", q, k) * scale
    p = _softmax(scores, axis=-1)
    return torch.einsum("bhqk,bhkd->bhqd", p, v)
```

```asm
; @launch grid=(256,1,1) block=(384,1,1) lds=153664
.amdgcn_target "amdgcn-amd-amdhsa--gfx950"
.text
.globl standalone__mha_softmax__sampling_kernel
.p2align 12
.p2align 8
.type standalone__mha_softmax__sampling_kernel,@function
standalone__mha_softmax__sampling_kernel:
  s_load_dwordx4 s[4:7], s[0:1], 0
  s_load_dwordx4 s[8:11], s[0:1], 16
  s_cmp_ge_u32 s2, 256
  s_cbranch_scc1 L_end
  v_readfirstlane_b32 s28, v0
  v_and_b32 v3, 15, v0
  v_bfe_u32 v8, v0, 4, 2
  v_xor_b32 v2, v8, v3
  v_lshlrev_b32 v2, 4, v2
  v_lshl_add_u32 v4, v8, 8, v2
  s_bfe_u32 s19, s2, 0x10002
  s_and_b32 s18, s2, 1
  s_lshl1_add_u32 s19, s19, s18
  s_lshr_b32 s18, s2, 7
  s_lshl1_add_u32 s19, s19, s18
  s_bfe_u32 s18, s2, 0x10001
  s_lshl1_add_u32 s19, s19, s18
  s_bfe_u32 s18, s2, 0x40003
  s_lshl4_add_u32 s19, s19, s18
  s_cmp_lg_u32 s28, 0
  s_cbranch_scc1 L_other
  s_lshr_b32 s18, s2, 1
  s_xor_b32 s18, s18, s2
  s_and_b32 s18, s18, 32
  s_lshl_b32 s17, s18, 8
  s_lshl_b32 s3, s19, 19
  s_mov_b32 m0, 0
  s_mov_b32 s14, 0x80000
  s_mov_b32 s15, 0x20000
  v_xor_b32 v5, 64, v4
  v_xor_b32 v6, 128, v4
  v_xor_b32 v7, 192, v4
  s_setprio 3
  s_mov_b32 s16, s17
  s_mov_b32 s29, 0
  s_mov_b32 s35, 0x1ffff
  s_movk_i32 s45, 0x2000
  s_movk_i32 s46, 0x3000
  s_mov_b32 s34, s14
  v_mov_b32 v10, 153600
  s_waitcnt lgkmcnt(0)
  s_add_u32 s12, s6, s3
  s_addc_u32 s13, s7, 0
  buffer_load_dwordx4 v4, s[12:15], s17 offen offset:0 nt lds
  buffer_load_dwordx4 v5, s[12:15], s17 offen offset:1024 nt lds
  buffer_load_dwordx4 v6, s[12:15], s17 offen offset:2048 nt lds
  buffer_load_dwordx4 v7, s[12:15], s17 offen offset:3072 nt lds
  s_addk_i32 s29, 0x1000
  s_and_b32 m0, s29, s35
  s_xor_b32 s17, s17, s45
  buffer_load_dwordx4 v4, s[12:15], s17 offen offset:0 nt lds
  buffer_load_dwordx4 v5, s[12:15], s17 offen offset:1024 nt lds
  buffer_load_dwordx4 v6, s[12:15], s17 offen offset:2048 nt lds
  buffer_load_dwordx4 v7, s[12:15], s17 offen offset:3072 nt lds
  s_addk_i32 s29, 0x1000
  s_and_b32 m0, s29, s35
  s_xor_b32 s17, s17, s46
  buffer_load_dwordx4 v4, s[12:15], s17 offen offset:0 nt lds
  buffer_load_dwordx4 v5, s[12:15], s17 offen offset:1024 nt lds
  buffer_load_dwordx4 v6, s[12:15], s17 offen offset:2048 nt lds
  buffer_load_dwordx4 v7, s[12:15], s17 offen offset:3072 nt lds
  s_addk_i32 s29, 0x1000
  s_and_b32 m0, s29, s35
  s_xor_b32 s17, s17, s45
  buffer_load_dwordx4 v4, s[12:15], s17 offen offset:0 nt lds
  buffer_load_dwordx4 v5, s[12:15], s17 offen offset:1024 nt lds
  buffer_load_dwordx4 v6, s[12:15], s17 offen offset:2048 nt lds
  buffer_load_dwordx4 v7, s[12:15], s17 offen offset:3072 nt lds
  s_addk_i32 s29, 0x1000
  s_and_b32 m0, s29, s35
  s_xor_b32 s17, s29, s16
  s_waitcnt vmcnt(18)
  buffer_load_dwordx4 v4, s[12:15], s17 offen offset:0 nt lds
  s_waitcnt vmcnt(18)
  buffer_load_dwordx4 v5, s[12:15], s17 offen offset:1024 nt lds
  s_waitcnt vmcnt(18)
  buffer_load_dwordx4 v6, s[12:15], s17 offen offset:2048 nt lds
  s_waitcnt vmcnt(18)
  buffer_load_dwordx4 v7, s[12:15], s17 offen offset:3072 nt lds
  s_addk_i32 s29, 0x1000
  s_and_b32 m0, s29, s35
  s_xor_b32 s17, s17, s45
  s_waitcnt vmcnt(18)
  buffer_load_dwordx4 v4, s[12:15], s17 offen offset:0 nt lds
  s_waitcnt vmcnt(18)
  buffer_load_dwordx4 v5, s[12:15], s17 offen offset:1024 nt lds
  s_waitcnt vmcnt(18)
  buffer_load_dwordx4 v6, s[12:15], s17 offen offset:2048 nt lds
  s_waitcnt vmcnt(18)
  buffer_load_dwordx4 v7, s[12:15], s17 offen offset:3072 nt lds
  s_addk_i32 s29, 0x1000
  s_and_b32 m0, s29, s35
  s_xor_b32 s17, s17, s46
  s_waitcnt vmcnt(18)
  buffer_load_dwordx4 v4, s[12:15], s17 offen offset:0 nt lds
  s_waitcnt vmcnt(18)
  buffer_load_dwordx4 v5, s[12:15], s17 offen offset:1024 nt lds
  s_waitcnt vmcnt(18)
  buffer_load_dwordx4 v6, s[12:15], s17 offen offset:2048 nt lds
  s_waitcnt vmcnt(18)
  buffer_load_dwordx4 v7, s[12:15], s17 offen offset:3072 nt lds
  s_addk_i32 s29, 0x1000
  s_and_b32 m0, s29, s35
  s_xor_b32 s17, s17, s45
  s_waitcnt vmcnt(18)
  buffer_load_dwordx4 v4, s[12:15], s17 offen offset:0 nt lds
  s_waitcnt vmcnt(18)
  buffer_load_dwordx4 v5, s[12:15], s17 offen offset:1024 nt lds
  s_waitcnt vmcnt(18)
  buffer_load_dwordx4 v6, s[12:15], s17 offen offset:2048 nt lds
  s_waitcnt vmcnt(18)
  buffer_load_dwordx4 v7, s[12:15], s17 offen offset:3072 nt lds
  s_addk_i32 s29, 0x1000
  s_and_b32 m0, s29, s35
  s_xor_b32 s17, s29, s16
L_d19:
  s_waitcnt vmcnt(18)
  buffer_load_dwordx4 v4, s[12:15], s17 offen offset:0 nt lds
  s_waitcnt vmcnt(18)
  buffer_load_dwordx4 v5, s[12:15], s17 offen offset:1024 nt lds
  s_waitcnt vmcnt(18)
  buffer_load_dwordx4 v6, s[12:15], s17 offen offset:2048 nt lds
  s_barrier
  s_waitcnt vmcnt(18)
  buffer_load_dwordx4 v7, s[12:15], s17 offen offset:3072 nt lds
  s_addk_i32 s29, 0x1000
  s_and_b32 m0, s29, s35
  s_xor_b32 s17, s17, s45
  s_waitcnt vmcnt(18)
  buffer_load_dwordx4 v4, s[12:15], s17 offen offset:0 nt lds
  s_waitcnt vmcnt(18)
  buffer_load_dwordx4 v5, s[12:15], s17 offen offset:1024 nt lds
  s_waitcnt vmcnt(18)
  buffer_load_dwordx4 v6, s[12:15], s17 offen offset:2048 nt lds
  s_waitcnt vmcnt(18)
  buffer_load_dwordx4 v7, s[12:15], s17 offen offset:3072 nt lds
  s_addk_i32 s29, 0x1000
  s_and_b32 m0, s29, s35
  s_xor_b32 s17, s17, s46
  s_waitcnt vmcnt(18)
  buffer_load_dwordx4 v4, s[12:15], s17 offen offset:0 nt lds
  s_waitcnt vmcnt(18)
  buffer_load_dwordx4 v5, s[12:15], s17 offen offset:1024 nt lds
  s_waitcnt vmcnt(18)
  buffer_load_dwordx4 v6, s[12:15], s17 offen offset:2048 nt lds
  s_waitcnt vmcnt(18)
  buffer_load_dwordx4 v7, s[12:15], s17 offen offset:3072 nt lds
  s_addk_i32 s29, 0x1000
  s_and_b32 m0, s29, s35
  s_xor_b32 s17, s17, s45
  s_waitcnt vmcnt(18)
  buffer_load_dwordx4 v4, s[12:15], s17 offen offset:0 nt lds
  ds_read_b32 v9, v10
  s_waitcnt vmcnt(18)
  buffer_load_dwordx4 v5, s[12:15], s17 offen offset:1024 nt lds
  s_waitcnt vmcnt(18)
  buffer_load_dwordx4 v6, s[12:15], s17 offen offset:2048 nt lds
  s_waitcnt vmcnt(18)
  buffer_load_dwordx4 v7, s[12:15], s17 offen offset:3072 nt lds
  s_addk_i32 s29, 0x1000
  s_and_b32 m0, s29, s35
  s_xor_b32 s17, s29, s16
  s_waitcnt lgkmcnt(0)
  v_readfirstlane_b32 s33, v9
  s_cmp_eq_u32 s29, s34
  s_cbranch_scc1 L_ev
  s_cmp_eq_u32 s33, 19
  s_cbranch_scc1 L_d19
  s_branch L_disp
L_d17:
  s_waitcnt vmcnt(16)
  buffer_load_dwordx4 v4, s[12:15], s17 offen offset:0 nt lds
  s_barrier
  s_waitcnt vmcnt(16)
  buffer_load_dwordx4 v5, s[12:15], s17 offen offset:1024 nt lds
  s_waitcnt vmcnt(16)
  buffer_load_dwordx4 v6, s[12:15], s17 offen offset:2048 nt lds
  s_waitcnt vmcnt(16)
  buffer_load_dwordx4 v7, s[12:15], s17 offen offset:3072 nt lds
  s_addk_i32 s29, 0x1000
  s_and_b32 m0, s29, s35
  s_xor_b32 s17, s17, s45
  s_waitcnt vmcnt(16)
  buffer_load_dwordx4 v4, s[12:15], s17 offen offset:0 nt lds
  s_waitcnt vmcnt(16)
  buffer_load_dwordx4 v5, s[12:15], s17 offen offset:1024 nt lds
  s_waitcnt vmcnt(16)
  buffer_load_dwordx4 v6, s[12:15], s17 offen offset:2048 nt lds
  s_waitcnt vmcnt(16)
  buffer_load_dwordx4 v7, s[12:15], s17 offen offset:3072 nt lds
  s_addk_i32 s29, 0x1000
  s_and_b32 m0, s29, s35
  s_xor_b32 s17, s17, s46
  s_waitcnt vmcnt(16)
  buffer_load_dwordx4 v4, s[12:15], s17 offen offset:0 nt lds
  s_waitcnt vmcnt(16)
  buffer_load_dwordx4 v5, s[12:15], s17 offen offset:1024 nt lds
  s_waitcnt vmcnt(16)
  buffer_load_dwordx4 v6, s[12:15], s17 offen offset:2048 nt lds
  s_waitcnt vmcnt(16)
  buffer_load_dwordx4 v7, s[12:15], s17 offen offset:3072 nt lds
  s_addk_i32 s29, 0x1000
  s_and_b32 m0, s29, s35
  s_xor_b32 s17, s17, s45
  s_waitcnt vmcnt(16)
  buffer_load_dwordx4 v4, s[12:15], s17 offen offset:0 nt lds
  ds_read_b32 v9, v10
  s_waitcnt vmcnt(16)
  buffer_load_dwordx4 v5, s[12:15], s17 offen offset:1024 nt lds
  s_waitcnt vmcnt(16)
  buffer_load_dwordx4 v6, s[12:15], s17 offen offset:2048 nt lds
  s_waitcnt vmcnt(16)
  buffer_load_dwordx4 v7, s[12:15], s17 offen offset:3072 nt lds
  s_addk_i32 s29, 0x1000
  s_and_b32 m0, s29, s35
  s_xor_b32 s17, s29, s16
  s_waitcnt lgkmcnt(0)
  v_readfirstlane_b32 s33, v9
  s_cmp_eq_u32 s29, s34
  s_cbranch_scc1 L_ev
  s_cmp_eq_u32 s33, 17
  s_cbranch_scc1 L_d17
  s_branch L_disp
L_d18:
  s_waitcnt vmcnt(17)
  buffer_load_dwordx4 v4, s[12:15], s17 offen offset:0 nt lds
  s_waitcnt vmcnt(17)
  buffer_load_dwordx4 v5, s[12:15], s17 offen offset:1024 nt lds
  s_barrier
  s_waitcnt vmcnt(17)
  buffer_load_dwordx4 v6, s[12:15], s17 offen offset:2048 nt lds
  s_waitcnt vmcnt(17)
  buffer_load_dwordx4 v7, s[12:15], s17 offen offset:3072 nt lds
  s_addk_i32 s29, 0x1000
  s_and_b32 m0, s29, s35
  s_xor_b32 s17, s17, s45
  s_waitcnt vmcnt(17)
  buffer_load_dwordx4 v4, s[12:15], s17 offen offset:0 nt lds
  s_waitcnt vmcnt(17)
  buffer_load_dwordx4 v5, s[12:15], s17 offen offset:1024 nt lds
  s_waitcnt vmcnt(17)
  buffer_load_dwordx4 v6, s[12:15], s17 offen offset:2048 nt lds
  s_waitcnt vmcnt(17)
  buffer_load_dwordx4 v7, s[12:15], s17 offen offset:3072 nt lds
  s_addk_i32 s29, 0x1000
  s_and_b32 m0, s29, s35
  s_xor_b32 s17, s17, s46
  s_waitcnt vmcnt(17)
  buffer_load_dwordx4 v4, s[12:15], s17 offen offset:0 nt lds
  s_waitcnt vmcnt(17)
  buffer_load_dwordx4 v5, s[12:15], s17 offen offset:1024 nt lds
  s_waitcnt vmcnt(17)
  buffer_load_dwordx4 v6, s[12:15], s17 offen offset:2048 nt lds
  s_waitcnt vmcnt(17)
  buffer_load_dwordx4 v7, s[12:15], s17 offen offset:3072 nt lds
  s_addk_i32 s29, 0x1000
  s_and_b32 m0, s29, s35
  s_xor_b32 s17, s17, s45
  s_waitcnt vmcnt(17)
  buffer_load_dwordx4 v4, s[12:15], s17 offen offset:0 nt lds
  ds_read_b32 v9, v10
  s_waitcnt vmcnt(17)
  buffer_load_dwordx4 v5, s[12:15], s17 offen offset:1024 nt lds
  s_waitcnt vmcnt(17)
  buffer_load_dwordx4 v6, s[12:15], s17 offen offset:2048 nt lds
  s_waitcnt vmcnt(17)
  buffer_load_dwordx4 v7, s[12:15], s17 offen offset:3072 nt lds
  s_addk_i32 s29, 0x1000
  s_and_b32 m0, s29, s35
  s_xor_b32 s17, s29, s16
  s_waitcnt lgkmcnt(0)
  v_readfirstlane_b32 s33, v9
  s_cmp_eq_u32 s29, s34
  s_cbranch_scc1 L_ev
  s_cmp_eq_u32 s33, 18
  s_cbranch_scc1 L_d18
  s_branch L_disp
L_d20:
  s_waitcnt vmcnt(19)
  buffer_load_dwordx4 v4, s[12:15], s17 offen offset:0 nt lds
  s_waitcnt vmcnt(19)
  buffer_load_dwordx4 v5, s[12:15], s17 offen offset:1024 nt lds
  s_waitcnt vmcnt(19)
  buffer_load_dwordx4 v6, s[12:15], s17 offen offset:2048 nt lds
  s_waitcnt vmcnt(19)
  buffer_load_dwordx4 v7, s[12:15], s17 offen offset:3072 nt lds
  s_barrier
  s_addk_i32 s29, 0x1000
  s_and_b32 m0, s29, s35
  s_xor_b32 s17, s17, s45
  s_waitcnt vmcnt(19)
  buffer_load_dwordx4 v4, s[12:15], s17 offen offset:0 nt lds
  s_waitcnt vmcnt(19)
  buffer_load_dwordx4 v5, s[12:15], s17 offen offset:1024 nt lds
  s_waitcnt vmcnt(19)
  buffer_load_dwordx4 v6, s[12:15], s17 offen offset:2048 nt lds
  s_waitcnt vmcnt(19)
  buffer_load_dwordx4 v7, s[12:15], s17 offen offset:3072 nt lds
  s_addk_i32 s29, 0x1000
  s_and_b32 m0, s29, s35
  s_xor_b32 s17, s17, s46
  s_waitcnt vmcnt(19)
  buffer_load_dwordx4 v4, s[12:15], s17 offen offset:0 nt lds
  s_waitcnt vmcnt(19)
  buffer_load_dwordx4 v5, s[12:15], s17 offen offset:1024 nt lds
  s_waitcnt vmcnt(19)
  buffer_load_dwordx4 v6, s[12:15], s17 offen offset:2048 nt lds
  s_waitcnt vmcnt(19)
  buffer_load_dwordx4 v7, s[12:15], s17 offen offset:3072 nt lds
  s_addk_i32 s29, 0x1000
  s_and_b32 m0, s29, s35
  s_xor_b32 s17, s17, s45
  s_waitcnt vmcnt(19)
  buffer_load_dwordx4 v4, s[12:15], s17 offen offset:0 nt lds
  ds_read_b32 v9, v10
  s_waitcnt vmcnt(19)
  buffer_load_dwordx4 v5, s[12:15], s17 offen offset:1024 nt lds
  s_waitcnt vmcnt(19)
  buffer_load_dwordx4 v6, s[12:15], s17 offen offset:2048 nt lds
  s_waitcnt vmcnt(19)
  buffer_load_dwordx4 v7, s[12:15], s17 offen offset:3072 nt lds
  s_addk_i32 s29, 0x1000
  s_and_b32 m0, s29, s35
  s_xor_b32 s17, s29, s16
  s_waitcnt lgkmcnt(0)
  v_readfirstlane_b32 s33, v9
  s_cmp_eq_u32 s29, s34
  s_cbranch_scc1 L_ev
  s_cmp_eq_u32 s33, 20
  s_cbranch_scc1 L_d20
  s_branch L_disp
L_d21:
  s_waitcnt vmcnt(20)
  buffer_load_dwordx4 v4, s[12:15], s17 offen offset:0 nt lds
  s_waitcnt vmcnt(20)
  buffer_load_dwordx4 v5, s[12:15], s17 offen offset:1024 nt lds
  s_waitcnt vmcnt(20)
  buffer_load_dwordx4 v6, s[12:15], s17 offen offset:2048 nt lds
  s_waitcnt vmcnt(20)
  buffer_load_dwordx4 v7, s[12:15], s17 offen offset:3072 nt lds
  s_addk_i32 s29, 0x1000
  s_and_b32 m0, s29, s35
  s_xor_b32 s17, s17, s45
  s_waitcnt vmcnt(20)
  buffer_load_dwordx4 v4, s[12:15], s17 offen offset:0 nt lds
  s_barrier
  s_waitcnt vmcnt(20)
  buffer_load_dwordx4 v5, s[12:15], s17 offen offset:1024 nt lds
  s_waitcnt vmcnt(20)
  buffer_load_dwordx4 v6, s[12:15], s17 offen offset:2048 nt lds
  s_waitcnt vmcnt(20)
  buffer_load_dwordx4 v7, s[12:15], s17 offen offset:3072 nt lds
  s_addk_i32 s29, 0x1000
  s_and_b32 m0, s29, s35
  s_xor_b32 s17, s17, s46
  s_waitcnt vmcnt(20)
  buffer_load_dwordx4 v4, s[12:15], s17 offen offset:0 nt lds
  s_waitcnt vmcnt(20)
  buffer_load_dwordx4 v5, s[12:15], s17 offen offset:1024 nt lds
  s_waitcnt vmcnt(20)
  buffer_load_dwordx4 v6, s[12:15], s17 offen offset:2048 nt lds
  s_waitcnt vmcnt(20)
  buffer_load_dwordx4 v7, s[12:15], s17 offen offset:3072 nt lds
  s_addk_i32 s29, 0x1000
  s_and_b32 m0, s29, s35
  s_xor_b32 s17, s17, s45
  s_waitcnt vmcnt(20)
  buffer_load_dwordx4 v4, s[12:15], s17 offen offset:0 nt lds
  ds_read_b32 v9, v10
  s_waitcnt vmcnt(20)
  buffer_load_dwordx4 v5, s[12:15], s17 offen offset:1024 nt lds
  s_waitcnt vmcnt(20)
  buffer_load_dwordx4 v6, s[12:15], s17 offen offset:2048 nt lds
  s_waitcnt vmcnt(20)
  buffer_load_dwordx4 v7, s[12:15], s17 offen offset:3072 nt lds
  s_addk_i32 s29, 0x1000
  s_and_b32 m0, s29, s35
  s_xor_b32 s17, s29, s16
  s_waitcnt lgkmcnt(0)
  v_readfirstlane_b32 s33, v9
  s_cmp_eq_u32 s29, s34
  s_cbranch_scc1 L_ev
  s_cmp_eq_u32 s33, 21
  s_cbranch_scc1 L_d21
  s_branch L_disp
L_d22:
  s_waitcnt vmcnt(21)
  buffer_load_dwordx4 v4, s[12:15], s17 offen offset:0 nt lds
  s_waitcnt vmcnt(21)
  buffer_load_dwordx4 v5, s[12:15], s17 offen offset:1024 nt lds
  s_waitcnt vmcnt(21)
  buffer_load_dwordx4 v6, s[12:15], s17 offen offset:2048 nt lds
  s_waitcnt vmcnt(21)
  buffer_load_dwordx4 v7, s[12:15], s17 offen offset:3072 nt lds
  s_addk_i32 s29, 0x1000
  s_and_b32 m0, s29, s35
  s_xor_b32 s17, s17, s45
  s_waitcnt vmcnt(21)
  buffer_load_dwordx4 v4, s[12:15], s17 offen offset:0 nt lds
  s_waitcnt vmcnt(21)
  buffer_load_dwordx4 v5, s[12:15], s17 offen offset:1024 nt lds
  s_barrier
  s_waitcnt vmcnt(21)
  buffer_load_dwordx4 v6, s[12:15], s17 offen offset:2048 nt lds
  s_waitcnt vmcnt(21)
  buffer_load_dwordx4 v7, s[12:15], s17 offen offset:3072 nt lds
  s_addk_i32 s29, 0x1000
  s_and_b32 m0, s29, s35
  s_xor_b32 s17, s17, s46
  s_waitcnt vmcnt(21)
  buffer_load_dwordx4 v4, s[12:15], s17 offen offset:0 nt lds
  s_waitcnt vmcnt(21)
  buffer_load_dwordx4 v5, s[12:15], s17 offen offset:1024 nt lds
  s_waitcnt vmcnt(21)
  buffer_load_dwordx4 v6, s[12:15], s17 offen offset:2048 nt lds
  s_waitcnt vmcnt(21)
  buffer_load_dwordx4 v7, s[12:15], s17 offen offset:3072 nt lds
  s_addk_i32 s29, 0x1000
  s_and_b32 m0, s29, s35
  s_xor_b32 s17, s17, s45
  s_waitcnt vmcnt(21)
  buffer_load_dwordx4 v4, s[12:15], s17 offen offset:0 nt lds
  ds_read_b32 v9, v10
  s_waitcnt vmcnt(21)
  buffer_load_dwordx4 v5, s[12:15], s17 offen offset:1024 nt lds
  s_waitcnt vmcnt(21)
  buffer_load_dwordx4 v6, s[12:15], s17 offen offset:2048 nt lds
  s_waitcnt vmcnt(21)
  buffer_load_dwordx4 v7, s[12:15], s17 offen offset:3072 nt lds
  s_addk_i32 s29, 0x1000
  s_and_b32 m0, s29, s35
  s_xor_b32 s17, s29, s16
  s_waitcnt lgkmcnt(0)
  v_readfirstlane_b32 s33, v9
  s_cmp_eq_u32 s29, s34
  s_cbranch_scc1 L_ev
  s_cmp_eq_u32 s33, 22
  s_cbranch_scc1 L_d22
  s_branch L_disp
L_d23:
  s_waitcnt vmcnt(22)
  buffer_load_dwordx4 v4, s[12:15], s17 offen offset:0 nt lds
  s_waitcnt vmcnt(22)
  buffer_load_dwordx4 v5, s[12:15], s17 offen offset:1024 nt lds
  s_waitcnt vmcnt(22)
  buffer_load_dwordx4 v6, s[12:15], s17 offen offset:2048 nt lds
  s_waitcnt vmcnt(22)
  buffer_load_dwordx4 v7, s[12:15], s17 offen offset:3072 nt lds
  s_addk_i32 s29, 0x1000
  s_and_b32 m0, s29, s35
  s_xor_b32 s17, s17, s45
  s_waitcnt vmcnt(22)
  buffer_load_dwordx4 v4, s[12:15], s17 offen offset:0 nt lds
  s_waitcnt vmcnt(22)
  buffer_load_dwordx4 v5, s[12:15], s17 offen offset:1024 nt lds
  s_waitcnt vmcnt(22)
  buffer_load_dwordx4 v6, s[12:15], s17 offen offset:2048 nt lds
  s_barrier
  s_waitcnt vmcnt(22)
  buffer_load_dwordx4 v7, s[12:15], s17 offen offset:3072 nt lds
  s_addk_i32 s29, 0x1000
  s_and_b32 m0, s29, s35
  s_xor_b32 s17, s17, s46
  s_waitcnt vmcnt(22)
  buffer_load_dwordx4 v4, s[12:15], s17 offen offset:0 nt lds
  s_waitcnt vmcnt(22)
  buffer_load_dwordx4 v5, s[12:15], s17 offen offset:1024 nt lds
  s_waitcnt vmcnt(22)
  buffer_load_dwordx4 v6, s[12:15], s17 offen offset:2048 nt lds
  s_waitcnt vmcnt(22)
  buffer_load_dwordx4 v7, s[12:15], s17 offen offset:3072 nt lds
  s_addk_i32 s29, 0x1000
  s_and_b32 m0, s29, s35
  s_xor_b32 s17, s17, s45
  s_waitcnt vmcnt(22)
  buffer_load_dwordx4 v4, s[12:15], s17 offen offset:0 nt lds
  ds_read_b32 v9, v10
  s_waitcnt vmcnt(22)
  buffer_load_dwordx4 v5, s[12:15], s17 offen offset:1024 nt lds
  s_waitcnt vmcnt(22)
  buffer_load_dwordx4 v6, s[12:15], s17 offen offset:2048 nt lds
  s_waitcnt vmcnt(22)
  buffer_load_dwordx4 v7, s[12:15], s17 offen offset:3072 nt lds
  s_addk_i32 s29, 0x1000
  s_and_b32 m0, s29, s35
  s_xor_b32 s17, s29, s16
  s_waitcnt lgkmcnt(0)
  v_readfirstlane_b32 s33, v9
  s_cmp_eq_u32 s29, s34
  s_cbranch_scc1 L_ev
  s_cmp_eq_u32 s33, 23
  s_cbranch_scc1 L_d23
  s_branch L_disp
L_ev:
  s_cmp_lg_u32 s29, s14
  s_cbranch_scc1 L_last
  s_add_u32 s12, s8, s3
  s_addc_u32 s13, s9, 0
  s_mov_b32 s29, 0
  s_mov_b32 s17, s16
  s_mov_b32 s34, 0x7c000
  v_lshlrev_b32 v1, 1, v8
  v_xor_b32 v1, v1, v3
  v_lshlrev_b32 v1, 4, v1
  v_lshl_add_u32 v4, v8, 8, v1
  v_xor_b32 v5, 128, v4
  v_mov_b32 v6, v4
  v_mov_b32 v7, v5
L_disp:
  s_cmp_ge_u32 s33, 20
  s_cbranch_scc1 L_th
  s_cmp_ge_u32 s33, 18
  s_cbranch_scc1 L_tlh
  s_branch L_d17
L_tlh:
  s_cmp_ge_u32 s33, 19
  s_cbranch_scc1 L_d19
  s_branch L_d18
L_th:
  s_cmp_ge_u32 s33, 22
  s_cbranch_scc1 L_thh
  s_cmp_ge_u32 s33, 21
  s_cbranch_scc1 L_d21
  s_branch L_d20
L_thh:
  s_cmp_ge_u32 s33, 23
  s_cbranch_scc1 L_d23
  s_branch L_d22
L_last:
  s_waitcnt vmcnt(19)
  buffer_load_dwordx4 v4, s[12:15], s17 offen offset:0 nt lds
  s_waitcnt vmcnt(19)
  buffer_load_dwordx4 v5, s[12:15], s17 offen offset:1024 nt lds
  s_waitcnt vmcnt(19)
  buffer_load_dwordx4 v6, s[12:15], s17 offen offset:2048 nt lds
  s_waitcnt vmcnt(19)
  buffer_load_dwordx4 v7, s[12:15], s17 offen offset:3072 nt lds
  s_barrier
  s_addk_i32 s29, 0x1000
  s_and_b32 m0, s29, s35
  s_xor_b32 s17, s17, s45
  buffer_load_dwordx4 v4, s[12:15], s17 offen offset:0 nt lds
  buffer_load_dwordx4 v5, s[12:15], s17 offen offset:1024 nt lds
  buffer_load_dwordx4 v6, s[12:15], s17 offen offset:2048 nt lds
  buffer_load_dwordx4 v7, s[12:15], s17 offen offset:3072 nt lds
  s_addk_i32 s29, 0x1000
  s_and_b32 m0, s29, s35
  s_xor_b32 s17, s17, s46
  buffer_load_dwordx4 v4, s[12:15], s17 offen offset:0 nt lds
  buffer_load_dwordx4 v5, s[12:15], s17 offen offset:1024 nt lds
  buffer_load_dwordx4 v6, s[12:15], s17 offen offset:2048 nt lds
  buffer_load_dwordx4 v7, s[12:15], s17 offen offset:3072 nt lds
  s_addk_i32 s29, 0x1000
  s_and_b32 m0, s29, s35
  s_xor_b32 s17, s17, s45
  buffer_load_dwordx4 v4, s[12:15], s17 offen offset:0 nt lds
  buffer_load_dwordx4 v5, s[12:15], s17 offen offset:1024 nt lds
  buffer_load_dwordx4 v6, s[12:15], s17 offen offset:2048 nt lds
  buffer_load_dwordx4 v7, s[12:15], s17 offen offset:3072 nt lds
  s_waitcnt vmcnt(16)
  s_barrier
  s_waitcnt vmcnt(8)
  s_barrier
  s_waitcnt vmcnt(0)
  s_barrier
  s_endpgm
L_other:
  s_lshr_b32 s28, s28, 6
  s_cmp_eq_u32 s28, 5
  s_cbranch_scc1 L_help
  s_sub_u32 s32, s28, 1
  s_lshl_b32 s33, s32, 10
  s_add_u32 m0, s33, 131072
  s_lshl_b32 s34, s32, 6
  v_xor_b32 v1, s34, v4
  s_lshl_b32 s35, s19, 12
  s_mov_b32 s22, 0x1000
  s_mov_b32 s23, 0x20000
  s_waitcnt lgkmcnt(0)
  s_add_u32 s20, s4, s35
  s_addc_u32 s21, s5, 0
  buffer_load_dwordx4 v1, s[20:23], s33 offen nt lds
  s_branch L_cons
L_help:
  s_load_dwordx2 s[16:17], s[0:1], 32
  v_mov_b32 v10, 153600
  v_mov_b32 v9, 19
  ds_write_b32 v10, v9
  s_and_b32 s33, s2, 7
  s_lshl_b32 s33, s33, 5
  s_lshr_b32 s34, s2, 3
  s_lshl_b32 s22, s34, 9
  s_add_u32 s34, s34, s33
  v_mov_b32 v4, s34
  v_and_b32 v5, 1, v0
  v_lshl_add_u32 v5, v5, 4, s33
  v_mov_b32 v7, 0
  s_mov_b32 s18, 5064
  s_getreg_b32 s35, hwreg(HW_REG_XCC_ID, 0, 1)
  s_mul_i32 s35, s35, 144
  s_sub_u32 s18, s18, s35
  s_lshl_b32 s3, s19, 19
  v_mov_b32 v26, s3
  v_and_b32 v24, 63, v0
  v_lshl_add_u32 v24, v24, 7, s22
  v_and_b32 v24, 16383, v24
  v_min_u32 v24, L_end-standalone__mha_softmax__sampling_kernel, v24
  s_getpc_b64 s[20:21]
L_pc:
  s_sub_u32 s20, s20, L_pc-standalone__mha_softmax__sampling_kernel
  s_subb_u32 s21, s21, 0
  v_mov_b32 v29, s21
  v_add_co_u32 v28, vcc, s20, v24
  s_nop 1
  v_addc_co_u32 v29, vcc, 0, v29, vcc
  s_mov_b64 exec, 3
  s_waitcnt lgkmcnt(0)
  global_load_dwordx4 v[12:15], v5, s[16:17] sc1
  global_load_dword v27, v26, s[8:9] nt
  s_mov_b64 exec, 15
  global_load_dword v25, v[28:29], off
  s_mov_b64 exec, 3
  s_barrier
  s_barrier
  v_mov_b32 v6, 3
  s_barrier
  global_store_byte v4, v6, s[16:17]
  v_mov_b32 v6, 4
  s_barrier
  global_store_byte v4, v6, s[16:17]
  v_mov_b32 v6, 5
  s_barrier
  global_store_byte v4, v6, s[16:17]
  global_load_dwordx4 v[12:15], v5, s[16:17] sc1
  s_mov_b32 s30, 28
L_ctl:
  v_lshlrev_b32 v11, 5, v6
  v_add_u32 v6, 1, v6
  s_barrier
  global_store_byte v4, v6, s[16:17]
  global_load_dwordx4 v[20:23], v5, s[16:17] sc1
  s_waitcnt vmcnt(2)
  v_sad_u8 v16, v12, 0, 0
  v_sad_u8 v16, v13, 0, v16
  v_sad_u8 v16, v14, 0, v16
  v_sad_u8 v16, v15, 0, v16
  v_subrev_u32 v11, 15, v11
  s_nop 0
  v_add_u32_dpp v16, v16, v16 quad_perm:[1,0,3,2] row_mask:0xf bank_mask:0xf
  v_sub_u32 v11, v11, v16
  v_cmp_gt_i32 vcc, 96, v11
  s_nop 1
  v_cndmask_b32 v11, 0, v11, vcc
  v_mul_i32_i24 v11, 16, v11
  v_sub_u32 v11, v11, v7
  v_ashrrev_i32 v11, 1, v11
  v_add_u32 v7, v7, v11
  v_sub_u32 v9, s18, v7
  v_ashrrev_i32 v9, 8, v9
  v_max_i32 v9, 17, v9
  v_min_i32 v9, 23, v9
  ds_write_b32 v10, v9
  v_lshlrev_b32 v11, 5, v6
  v_add_u32 v6, 1, v6
  s_barrier
  global_store_byte v4, v6, s[16:17]
  global_load_dwordx4 v[12:15], v5, s[16:17] sc1
  s_waitcnt vmcnt(2)
  v_sad_u8 v16, v20, 0, 0
  v_sad_u8 v16, v21, 0, v16
  v_sad_u8 v16, v22, 0, v16
  v_sad_u8 v16, v23, 0, v16
  v_subrev_u32 v11, 15, v11
  s_nop 0
  v_add_u32_dpp v16, v16, v16 quad_perm:[1,0,3,2] row_mask:0xf bank_mask:0xf
  v_sub_u32 v11, v11, v16
  v_cmp_gt_i32 vcc, 96, v11
  s_nop 1
  v_cndmask_b32 v11, 0, v11, vcc
  v_mul_i32_i24 v11, 16, v11
  v_sub_u32 v11, v11, v7
  v_ashrrev_i32 v11, 1, v11
  v_add_u32 v7, v7, v11
  v_sub_u32 v9, s18, v7
  v_ashrrev_i32 v9, 8, v9
  v_max_i32 v9, 17, v9
  v_min_i32 v9, 23, v9
  ds_write_b32 v10, v9
  s_sub_u32 s30, s30, 1
  s_cmp_lg_u32 s30, 0
  s_cbranch_scc1 L_ctl
  s_barrier
  s_barrier
  s_barrier
  s_barrier
  s_endpgm
L_cons:
  s_add_u32 s24, s10, s35
  s_addc_u32 s25, s11, 0
  s_mov_b32 s26, 0x1000
  s_mov_b32 s27, 0x20000
  v_lshl_add_u32 v10, v3, 8, v2
  v_add_u32 v10, 131072, v10
  v_xor_b32 v11, 64, v10
  v_xor_b32 v12, 128, v10
  v_xor_b32 v13, 192, v10
  v_and_b32 v9, 63, v0
  v_lshrrev_b32 v1, 2, v9
  v_and_b32 v2, 7, v1
  v_lshlrev_b32 v2, 5, v2
  v_xor_b32 v2, s34, v2
  v_lshl_add_u32 v1, v1, 8, v2
  v_and_b32 v2, 3, v0
  v_lshl_add_u32 v14, v2, 3, v1
  v_xor_b32 v15, 32, v14
  v_lshlrev_b32 v1, 4, v9
  v_add_u32 v5, 135168, v1
  s_lshr_b32 s35, s32, 1
  s_lshl_b32 s35, s35, 10
  s_and_b32 s18, s32, 1
  s_lshl_b32 s18, s18, 3
  s_add_u32 s35, s35, s18
  v_add_u32 v4, s35, v5
  s_lshl_b32 s18, s32, 2
  v_add_u32 v6, s18, v5
  v_lshrrev_b32 v1, 2, v9
  v_and_b32 v2, 3, v9
  v_lshlrev_b32 v7, 8, v1
  v_lshl_add_u32 v7, v2, 4, v7
  v_bfrev_b32 v2, v2
  v_lshrrev_b32 v2, 26, v2
  v_add_lshl_u32 v18, v1, v2, 2
  v_add_u32 v7, s34, v7
  s_mov_b32 s31, 0x3e0293ee
  s_lshl_b32 s18, s32, 12
  s_sub_u32 s18, s18, 131072
  s_waitcnt vmcnt(0)
  s_barrier
  ds_read_b128 v[60:63], v10
  ds_read_b128 v[64:67], v11
  ds_read_b128 v[68:71], v12
  ds_read_b128 v[72:75], v13
  v_add_u32 v10, s18, v10
  v_add_u32 v11, s18, v11
  v_add_u32 v12, s18, v12
  v_add_u32 v13, s18, v13
  ds_read_b128 v[44:47], v10 offset:0
  ds_read_b128 v[48:51], v11 offset:0
  ds_read_b128 v[52:55], v12 offset:0
  ds_read_b128 v[56:59], v13 offset:0
  s_waitcnt lgkmcnt(3)
  v_mfma_f32_16x16x32_bf16 v[76:79], v[44:47], v[60:63], 0
  s_waitcnt lgkmcnt(2)
  v_mfma_f32_16x16x32_bf16 v[76:79], v[48:51], v[64:67], v[76:79]
  s_waitcnt lgkmcnt(1)
  v_mfma_f32_16x16x32_bf16 v[76:79], v[52:55], v[68:71], v[76:79]
  s_waitcnt lgkmcnt(0)
  v_mfma_f32_16x16x32_bf16 v[76:79], v[56:59], v[72:75], v[76:79]
  s_barrier
  ds_read_b128 v[44:47], v10 offset:16384
  ds_read_b128 v[48:51], v11 offset:16384
  ds_read_b128 v[52:55], v12 offset:16384
  ds_read_b128 v[56:59], v13 offset:16384
  s_waitcnt lgkmcnt(3)
  v_mfma_f32_16x16x32_bf16 v[80:83], v[44:47], v[60:63], 0
  s_waitcnt lgkmcnt(2)
  v_mfma_f32_16x16x32_bf16 v[80:83], v[48:51], v[64:67], v[80:83]
  s_waitcnt lgkmcnt(1)
  v_mfma_f32_16x16x32_bf16 v[80:83], v[52:55], v[68:71], v[80:83]
  s_waitcnt lgkmcnt(0)
  v_mfma_f32_16x16x32_bf16 v[80:83], v[56:59], v[72:75], v[80:83]
  s_barrier
  ds_read_b128 v[44:47], v10 offset:32768
  ds_read_b128 v[48:51], v11 offset:32768
  ds_read_b128 v[52:55], v12 offset:32768
  ds_read_b128 v[56:59], v13 offset:32768
  v_max3_f32 v16, v76, v77, v78
  v_max_f32 v16, v16, v79
  s_waitcnt lgkmcnt(3)
  v_mfma_f32_16x16x32_bf16 v[84:87], v[44:47], v[60:63], 0
  s_waitcnt lgkmcnt(2)
  v_mfma_f32_16x16x32_bf16 v[84:87], v[48:51], v[64:67], v[84:87]
  s_waitcnt lgkmcnt(1)
  v_mfma_f32_16x16x32_bf16 v[84:87], v[52:55], v[68:71], v[84:87]
  s_waitcnt lgkmcnt(0)
  v_mfma_f32_16x16x32_bf16 v[84:87], v[56:59], v[72:75], v[84:87]
  s_barrier
  ds_read_b128 v[44:47], v10 offset:49152
  ds_read_b128 v[48:51], v11 offset:49152
  ds_read_b128 v[52:55], v12 offset:49152
  ds_read_b128 v[56:59], v13 offset:49152
  v_xor_b32 v10, 0x10000, v10
  v_xor_b32 v11, 0x10000, v11
  v_xor_b32 v12, 0x10000, v12
  v_xor_b32 v13, 0x10000, v13
  v_max3_f32 v16, v16, v80, v81
  v_max3_f32 v16, v16, v82, v83
  s_waitcnt lgkmcnt(3)
  v_mfma_f32_16x16x32_bf16 v[88:91], v[44:47], v[60:63], 0
  s_waitcnt lgkmcnt(2)
  v_mfma_f32_16x16x32_bf16 v[88:91], v[48:51], v[64:67], v[88:91]
  s_waitcnt lgkmcnt(1)
  v_mfma_f32_16x16x32_bf16 v[88:91], v[52:55], v[68:71], v[88:91]
  s_waitcnt lgkmcnt(0)
  v_mfma_f32_16x16x32_bf16 v[88:91], v[56:59], v[72:75], v[88:91]
  s_barrier
  ds_read_b128 v[44:47], v10 offset:0
  ds_read_b128 v[48:51], v11 offset:0
  ds_read_b128 v[52:55], v12 offset:0
  ds_read_b128 v[56:59], v13 offset:0
  v_max3_f32 v16, v16, v84, v85
  v_max3_f32 v16, v16, v86, v87
  s_waitcnt lgkmcnt(3)
  v_mfma_f32_16x16x32_bf16 v[92:95], v[44:47], v[60:63], 0
  s_waitcnt lgkmcnt(2)
  v_mfma_f32_16x16x32_bf16 v[92:95], v[48:51], v[64:67], v[92:95]
  s_waitcnt lgkmcnt(1)
  v_mfma_f32_16x16x32_bf16 v[92:95], v[52:55], v[68:71], v[92:95]
  s_waitcnt lgkmcnt(0)
  v_mfma_f32_16x16x32_bf16 v[92:95], v[56:59], v[72:75], v[92:95]
  s_barrier
  ds_read_b128 v[44:47], v10 offset:16384
  ds_read_b128 v[48:51], v11 offset:16384
  ds_read_b128 v[52:55], v12 offset:16384
  ds_read_b128 v[56:59], v13 offset:16384
  v_max3_f32 v16, v16, v88, v89
  v_max3_f32 v16, v16, v90, v91
  s_waitcnt lgkmcnt(3)
  v_mfma_f32_16x16x32_bf16 v[96:99], v[44:47], v[60:63], 0
  s_waitcnt lgkmcnt(2)
  v_mfma_f32_16x16x32_bf16 v[96:99], v[48:51], v[64:67], v[96:99]
  s_waitcnt lgkmcnt(1)
  v_mfma_f32_16x16x32_bf16 v[96:99], v[52:55], v[68:71], v[96:99]
  s_waitcnt lgkmcnt(0)
  v_mfma_f32_16x16x32_bf16 v[96:99], v[56:59], v[72:75], v[96:99]
  s_barrier
  ds_read_b128 v[44:47], v10 offset:32768
  ds_read_b128 v[48:51], v11 offset:32768
  ds_read_b128 v[52:55], v12 offset:32768
  ds_read_b128 v[56:59], v13 offset:32768
  v_max3_f32 v16, v16, v92, v93
  v_max3_f32 v16, v16, v94, v95
  s_waitcnt lgkmcnt(3)
  v_mfma_f32_16x16x32_bf16 v[100:103], v[44:47], v[60:63], 0
  s_waitcnt lgkmcnt(2)
  v_mfma_f32_16x16x32_bf16 v[100:103], v[48:51], v[64:67], v[100:103]
  s_waitcnt lgkmcnt(1)
  v_mfma_f32_16x16x32_bf16 v[100:103], v[52:55], v[68:71], v[100:103]
  s_waitcnt lgkmcnt(0)
  v_mfma_f32_16x16x32_bf16 v[100:103], v[56:59], v[72:75], v[100:103]
  s_barrier
  ds_read_b128 v[44:47], v10 offset:49152
  ds_read_b128 v[48:51], v11 offset:49152
  ds_read_b128 v[52:55], v12 offset:49152
  ds_read_b128 v[56:59], v13 offset:49152
  v_xor_b32 v10, 0x10000, v10
  v_xor_b32 v11, 0x10000, v11
  v_xor_b32 v12, 0x10000, v12
  v_xor_b32 v13, 0x10000, v13
  v_max3_f32 v16, v16, v96, v97
  v_max3_f32 v16, v16, v98, v99
  s_waitcnt lgkmcnt(3)
  v_mfma_f32_16x16x32_bf16 v[104:107], v[44:47], v[60:63], 0
  s_waitcnt lgkmcnt(2)
  v_mfma_f32_16x16x32_bf16 v[104:107], v[48:51], v[64:67], v[104:107]
  s_waitcnt lgkmcnt(1)
  v_mfma_f32_16x16x32_bf16 v[104:107], v[52:55], v[68:71], v[104:107]
  s_waitcnt lgkmcnt(0)
  v_mfma_f32_16x16x32_bf16 v[104:107], v[56:59], v[72:75], v[104:107]
  s_barrier
  ds_read_b128 v[44:47], v10 offset:0
  ds_read_b128 v[48:51], v11 offset:0
  ds_read_b128 v[52:55], v12 offset:0
  ds_read_b128 v[56:59], v13 offset:0
  v_max3_f32 v16, v16, v100, v101
  v_max3_f32 v16, v16, v102, v103
  s_waitcnt lgkmcnt(3)
  v_mfma_f32_16x16x32_bf16 v[108:111], v[44:47], v[60:63], 0
  s_waitcnt lgkmcnt(2)
  v_mfma_f32_16x16x32_bf16 v[108:111], v[48:51], v[64:67], v[108:111]
  s_waitcnt lgkmcnt(1)
  v_mfma_f32_16x16x32_bf16 v[108:111], v[52:55], v[68:71], v[108:111]
  s_waitcnt lgkmcnt(0)
  v_mfma_f32_16x16x32_bf16 v[108:111], v[56:59], v[72:75], v[108:111]
  s_barrier
  ds_read_b128 v[44:47], v10 offset:16384
  ds_read_b128 v[48:51], v11 offset:16384
  ds_read_b128 v[52:55], v12 offset:16384
  ds_read_b128 v[56:59], v13 offset:16384
  v_max3_f32 v16, v16, v104, v105
  v_max3_f32 v16, v16, v106, v107
  s_waitcnt lgkmcnt(3)
  v_mfma_f32_16x16x32_bf16 v[112:115], v[44:47], v[60:63], 0
  s_waitcnt lgkmcnt(2)
  v_mfma_f32_16x16x32_bf16 v[112:115], v[48:51], v[64:67], v[112:115]
  s_waitcnt lgkmcnt(1)
  v_mfma_f32_16x16x32_bf16 v[112:115], v[52:55], v[68:71], v[112:115]
  s_waitcnt lgkmcnt(0)
  v_mfma_f32_16x16x32_bf16 v[112:115], v[56:59], v[72:75], v[112:115]
  s_barrier
  ds_read_b128 v[44:47], v10 offset:32768
  ds_read_b128 v[48:51], v11 offset:32768
  ds_read_b128 v[52:55], v12 offset:32768
  ds_read_b128 v[56:59], v13 offset:32768
  v_max3_f32 v16, v16, v108, v109
  v_max3_f32 v16, v16, v110, v111
  s_waitcnt lgkmcnt(3)
  v_mfma_f32_16x16x32_bf16 v[116:119], v[44:47], v[60:63], 0
  s_waitcnt lgkmcnt(2)
  v_mfma_f32_16x16x32_bf16 v[116:119], v[48:51], v[64:67], v[116:119]
  s_waitcnt lgkmcnt(1)
  v_mfma_f32_16x16x32_bf16 v[116:119], v[52:55], v[68:71], v[116:119]
  s_waitcnt lgkmcnt(0)
  v_mfma_f32_16x16x32_bf16 v[116:119], v[56:59], v[72:75], v[116:119]
  s_barrier
  ds_read_b128 v[44:47], v10 offset:49152
  ds_read_b128 v[48:51], v11 offset:49152
  ds_read_b128 v[52:55], v12 offset:49152
  ds_read_b128 v[56:59], v13 offset:49152
  v_xor_b32 v10, 0x10000, v10
  v_xor_b32 v11, 0x10000, v11
  v_xor_b32 v12, 0x10000, v12
  v_xor_b32 v13, 0x10000, v13
  v_max3_f32 v16, v16, v112, v113
  v_max3_f32 v16, v16, v114, v115
  s_waitcnt lgkmcnt(3)
  v_mfma_f32_16x16x32_bf16 v[120:123], v[44:47], v[60:63], 0
  s_waitcnt lgkmcnt(2)
  v_mfma_f32_16x16x32_bf16 v[120:123], v[48:51], v[64:67], v[120:123]
  s_waitcnt lgkmcnt(1)
  v_mfma_f32_16x16x32_bf16 v[120:123], v[52:55], v[68:71], v[120:123]
  s_waitcnt lgkmcnt(0)
  v_mfma_f32_16x16x32_bf16 v[120:123], v[56:59], v[72:75], v[120:123]
  s_barrier
  ds_read_b128 v[44:47], v10 offset:0
  ds_read_b128 v[48:51], v11 offset:0
  ds_read_b128 v[52:55], v12 offset:0
  ds_read_b128 v[56:59], v13 offset:0
  v_max3_f32 v16, v16, v116, v117
  v_max3_f32 v16, v16, v118, v119
  s_waitcnt lgkmcnt(3)
  v_mfma_f32_16x16x32_bf16 v[124:127], v[44:47], v[60:63], 0
  s_waitcnt lgkmcnt(2)
  v_mfma_f32_16x16x32_bf16 v[124:127], v[48:51], v[64:67], v[124:127]
  s_waitcnt lgkmcnt(1)
  v_mfma_f32_16x16x32_bf16 v[124:127], v[52:55], v[68:71], v[124:127]
  s_waitcnt lgkmcnt(0)
  v_mfma_f32_16x16x32_bf16 v[124:127], v[56:59], v[72:75], v[124:127]
  s_barrier
  ds_read_b128 v[44:47], v10 offset:16384
  ds_read_b128 v[48:51], v11 offset:16384
  ds_read_b128 v[52:55], v12 offset:16384
  ds_read_b128 v[56:59], v13 offset:16384
  v_max3_f32 v16, v16, v120, v121
  v_max3_f32 v16, v16, v122, v123
  s_waitcnt lgkmcnt(3)
  v_mfma_f32_16x16x32_bf16 v[128:131], v[44:47], v[60:63], 0
  s_waitcnt lgkmcnt(2)
  v_mfma_f32_16x16x32_bf16 v[128:131], v[48:51], v[64:67], v[128:131]
  s_waitcnt lgkmcnt(1)
  v_mfma_f32_16x16x32_bf16 v[128:131], v[52:55], v[68:71], v[128:131]
  s_waitcnt lgkmcnt(0)
  v_mfma_f32_16x16x32_bf16 v[128:131], v[56:59], v[72:75], v[128:131]
  s_barrier
  ds_read_b128 v[44:47], v10 offset:32768
  ds_read_b128 v[48:51], v11 offset:32768
  ds_read_b128 v[52:55], v12 offset:32768
  ds_read_b128 v[56:59], v13 offset:32768
  v_max3_f32 v16, v16, v124, v125
  v_max3_f32 v16, v16, v126, v127
  s_waitcnt lgkmcnt(3)
  v_mfma_f32_16x16x32_bf16 v[132:135], v[44:47], v[60:63], 0
  s_waitcnt lgkmcnt(2)
  v_mfma_f32_16x16x32_bf16 v[132:135], v[48:51], v[64:67], v[132:135]
  s_waitcnt lgkmcnt(1)
  v_mfma_f32_16x16x32_bf16 v[132:135], v[52:55], v[68:71], v[132:135]
  s_waitcnt lgkmcnt(0)
  v_mfma_f32_16x16x32_bf16 v[132:135], v[56:59], v[72:75], v[132:135]
  s_barrier
  ds_read_b128 v[44:47], v10 offset:49152
  ds_read_b128 v[48:51], v11 offset:49152
  ds_read_b128 v[52:55], v12 offset:49152
  ds_read_b128 v[56:59], v13 offset:49152
  v_xor_b32 v10, 0x10000, v10
  v_xor_b32 v11, 0x10000, v11
  v_xor_b32 v12, 0x10000, v12
  v_xor_b32 v13, 0x10000, v13
  v_max3_f32 v16, v16, v128, v129
  v_max3_f32 v16, v16, v130, v131
  s_waitcnt lgkmcnt(3)
  v_mfma_f32_16x16x32_bf16 v[136:139], v[44:47], v[60:63], 0
  s_waitcnt lgkmcnt(2)
  v_mfma_f32_16x16x32_bf16 v[136:139], v[48:51], v[64:67], v[136:139]
  s_waitcnt lgkmcnt(1)
  v_mfma_f32_16x16x32_bf16 v[136:139], v[52:55], v[68:71], v[136:139]
  s_waitcnt lgkmcnt(0)
  v_mfma_f32_16x16x32_bf16 v[136:139], v[56:59], v[72:75], v[136:139]
  s_barrier
  ds_read_b128 v[44:47], v10 offset:0
  ds_read_b128 v[48:51], v11 offset:0
  ds_read_b128 v[52:55], v12 offset:0
  ds_read_b128 v[56:59], v13 offset:0
  v_max3_f32 v16, v16, v132, v133
  v_max3_f32 v16, v16, v134, v135
  s_waitcnt lgkmcnt(3)
  v_mfma_f32_16x16x32_bf16 v[140:143], v[44:47], v[60:63], 0
  s_waitcnt lgkmcnt(2)
  v_mfma_f32_16x16x32_bf16 v[140:143], v[48:51], v[64:67], v[140:143]
  s_waitcnt lgkmcnt(1)
  v_mfma_f32_16x16x32_bf16 v[140:143], v[52:55], v[68:71], v[140:143]
  s_waitcnt lgkmcnt(0)
  v_mfma_f32_16x16x32_bf16 v[140:143], v[56:59], v[72:75], v[140:143]
  s_barrier
  ds_read_b128 v[44:47], v10 offset:16384
  ds_read_b128 v[48:51], v11 offset:16384
  ds_read_b128 v[52:55], v12 offset:16384
  ds_read_b128 v[56:59], v13 offset:16384
  v_max3_f32 v16, v16, v136, v137
  v_max3_f32 v16, v16, v138, v139
  s_waitcnt lgkmcnt(3)
  v_mfma_f32_16x16x32_bf16 v[144:147], v[44:47], v[60:63], 0
  s_waitcnt lgkmcnt(2)
  v_mfma_f32_16x16x32_bf16 v[144:147], v[48:51], v[64:67], v[144:147]
  s_waitcnt lgkmcnt(1)
  v_mfma_f32_16x16x32_bf16 v[144:147], v[52:55], v[68:71], v[144:147]
  s_waitcnt lgkmcnt(0)
  v_mfma_f32_16x16x32_bf16 v[144:147], v[56:59], v[72:75], v[144:147]
  s_barrier
  ds_read_b128 v[44:47], v10 offset:32768
  ds_read_b128 v[48:51], v11 offset:32768
  ds_read_b128 v[52:55], v12 offset:32768
  ds_read_b128 v[56:59], v13 offset:32768
  v_max3_f32 v16, v16, v140, v141
  v_max3_f32 v16, v16, v142, v143
  s_waitcnt lgkmcnt(3)
  v_mfma_f32_16x16x32_bf16 v[148:151], v[44:47], v[60:63], 0
  s_waitcnt lgkmcnt(2)
  v_mfma_f32_16x16x32_bf16 v[148:151], v[48:51], v[64:67], v[148:151]
  s_waitcnt lgkmcnt(1)
  v_mfma_f32_16x16x32_bf16 v[148:151], v[52:55], v[68:71], v[148:151]
  s_waitcnt lgkmcnt(0)
  v_mfma_f32_16x16x32_bf16 v[148:151], v[56:59], v[72:75], v[148:151]
  s_barrier
  ds_read_b128 v[44:47], v10 offset:49152
  ds_read_b128 v[48:51], v11 offset:49152
  ds_read_b128 v[52:55], v12 offset:49152
  ds_read_b128 v[56:59], v13 offset:49152
  v_xor_b32 v10, 0x10000, v10
  v_xor_b32 v11, 0x10000, v11
  v_xor_b32 v12, 0x10000, v12
  v_xor_b32 v13, 0x10000, v13
  v_max3_f32 v16, v16, v144, v145
  v_max3_f32 v16, v16, v146, v147
  s_waitcnt lgkmcnt(3)
  v_mfma_f32_16x16x32_bf16 v[152:155], v[44:47], v[60:63], 0
  s_waitcnt lgkmcnt(2)
  v_mfma_f32_16x16x32_bf16 v[152:155], v[48:51], v[64:67], v[152:155]
  s_waitcnt lgkmcnt(1)
  v_mfma_f32_16x16x32_bf16 v[152:155], v[52:55], v[68:71], v[152:155]
  s_waitcnt lgkmcnt(0)
  v_mfma_f32_16x16x32_bf16 v[152:155], v[56:59], v[72:75], v[152:155]
  s_barrier
  ds_read_b128 v[44:47], v10 offset:0
  ds_read_b128 v[48:51], v11 offset:0
  ds_read_b128 v[52:55], v12 offset:0
  ds_read_b128 v[56:59], v13 offset:0
  v_max3_f32 v16, v16, v148, v149
  v_max3_f32 v16, v16, v150, v151
  s_waitcnt lgkmcnt(3)
  v_mfma_f32_16x16x32_bf16 v[156:159], v[44:47], v[60:63], 0
  s_waitcnt lgkmcnt(2)
  v_mfma_f32_16x16x32_bf16 v[156:159], v[48:51], v[64:67], v[156:159]
  s_waitcnt lgkmcnt(1)
  v_mfma_f32_16x16x32_bf16 v[156:159], v[52:55], v[68:71], v[156:159]
  s_waitcnt lgkmcnt(0)
  v_mfma_f32_16x16x32_bf16 v[156:159], v[56:59], v[72:75], v[156:159]
  s_barrier
  ds_read_b128 v[44:47], v10 offset:16384
  ds_read_b128 v[48:51], v11 offset:16384
  ds_read_b128 v[52:55], v12 offset:16384
  ds_read_b128 v[56:59], v13 offset:16384
  v_max3_f32 v16, v16, v152, v153
  v_max3_f32 v16, v16, v154, v155
  s_waitcnt lgkmcnt(3)
  v_mfma_f32_16x16x32_bf16 v[160:163], v[44:47], v[60:63], 0
  s_waitcnt lgkmcnt(2)
  v_mfma_f32_16x16x32_bf16 v[160:163], v[48:51], v[64:67], v[160:163]
  s_waitcnt lgkmcnt(1)
  v_mfma_f32_16x16x32_bf16 v[160:163], v[52:55], v[68:71], v[160:163]
  s_waitcnt lgkmcnt(0)
  v_mfma_f32_16x16x32_bf16 v[160:163], v[56:59], v[72:75], v[160:163]
  s_barrier
  ds_read_b128 v[44:47], v10 offset:32768
  ds_read_b128 v[48:51], v11 offset:32768
  ds_read_b128 v[52:55], v12 offset:32768
  ds_read_b128 v[56:59], v13 offset:32768
  v_max3_f32 v16, v16, v156, v157
  v_max3_f32 v16, v16, v158, v159
  s_waitcnt lgkmcnt(3)
  v_mfma_f32_16x16x32_bf16 v[164:167], v[44:47], v[60:63], 0
  s_waitcnt lgkmcnt(2)
  v_mfma_f32_16x16x32_bf16 v[164:167], v[48:51], v[64:67], v[164:167]
  s_waitcnt lgkmcnt(1)
  v_mfma_f32_16x16x32_bf16 v[164:167], v[52:55], v[68:71], v[164:167]
  s_waitcnt lgkmcnt(0)
  v_mfma_f32_16x16x32_bf16 v[164:167], v[56:59], v[72:75], v[164:167]
  s_barrier
  ds_read_b128 v[44:47], v10 offset:49152
  ds_read_b128 v[48:51], v11 offset:49152
  ds_read_b128 v[52:55], v12 offset:49152
  ds_read_b128 v[56:59], v13 offset:49152
  v_xor_b32 v10, 0x10000, v10
  v_xor_b32 v11, 0x10000, v11
  v_xor_b32 v12, 0x10000, v12
  v_xor_b32 v13, 0x10000, v13
  v_max3_f32 v16, v16, v160, v161
  v_max3_f32 v16, v16, v162, v163
  s_waitcnt lgkmcnt(3)
  v_mfma_f32_16x16x32_bf16 v[168:171], v[44:47], v[60:63], 0
  s_waitcnt lgkmcnt(2)
  v_mfma_f32_16x16x32_bf16 v[168:171], v[48:51], v[64:67], v[168:171]
  s_waitcnt lgkmcnt(1)
  v_mfma_f32_16x16x32_bf16 v[168:171], v[52:55], v[68:71], v[168:171]
  s_waitcnt lgkmcnt(0)
  v_mfma_f32_16x16x32_bf16 v[168:171], v[56:59], v[72:75], v[168:171]
  s_barrier
  ds_read_b128 v[44:47], v10 offset:0
  ds_read_b128 v[48:51], v11 offset:0
  ds_read_b128 v[52:55], v12 offset:0
  ds_read_b128 v[56:59], v13 offset:0
  v_max3_f32 v16, v16, v164, v165
  v_max3_f32 v16, v16, v166, v167
  s_waitcnt lgkmcnt(3)
  v_mfma_f32_16x16x32_bf16 v[172:175], v[44:47], v[60:63], 0
  s_waitcnt lgkmcnt(2)
  v_mfma_f32_16x16x32_bf16 v[172:175], v[48:51], v[64:67], v[172:175]
  s_waitcnt lgkmcnt(1)
  v_mfma_f32_16x16x32_bf16 v[172:175], v[52:55], v[68:71], v[172:175]
  s_waitcnt lgkmcnt(0)
  v_mfma_f32_16x16x32_bf16 v[172:175], v[56:59], v[72:75], v[172:175]
  s_barrier
  ds_read_b128 v[44:47], v10 offset:16384
  ds_read_b128 v[48:51], v11 offset:16384
  ds_read_b128 v[52:55], v12 offset:16384
  ds_read_b128 v[56:59], v13 offset:16384
  v_max3_f32 v16, v16, v168, v169
  v_max3_f32 v16, v16, v170, v171
  s_waitcnt lgkmcnt(3)
  v_mfma_f32_16x16x32_bf16 v[176:179], v[44:47], v[60:63], 0
  s_waitcnt lgkmcnt(2)
  v_mfma_f32_16x16x32_bf16 v[176:179], v[48:51], v[64:67], v[176:179]
  s_waitcnt lgkmcnt(1)
  v_mfma_f32_16x16x32_bf16 v[176:179], v[52:55], v[68:71], v[176:179]
  s_waitcnt lgkmcnt(0)
  v_mfma_f32_16x16x32_bf16 v[176:179], v[56:59], v[72:75], v[176:179]
  s_barrier
  ds_read_b128 v[44:47], v10 offset:32768
  ds_read_b128 v[48:51], v11 offset:32768
  ds_read_b128 v[52:55], v12 offset:32768
  ds_read_b128 v[56:59], v13 offset:32768
  v_max3_f32 v16, v16, v172, v173
  v_max3_f32 v16, v16, v174, v175
  s_waitcnt lgkmcnt(3)
  v_mfma_f32_16x16x32_bf16 v[180:183], v[44:47], v[60:63], 0
  s_waitcnt lgkmcnt(2)
  v_mfma_f32_16x16x32_bf16 v[180:183], v[48:51], v[64:67], v[180:183]
  s_waitcnt lgkmcnt(1)
  v_mfma_f32_16x16x32_bf16 v[180:183], v[52:55], v[68:71], v[180:183]
  s_waitcnt lgkmcnt(0)
  v_mfma_f32_16x16x32_bf16 v[180:183], v[56:59], v[72:75], v[180:183]
  s_barrier
  ds_read_b128 v[44:47], v10 offset:49152
  ds_read_b128 v[48:51], v11 offset:49152
  ds_read_b128 v[52:55], v12 offset:49152
  ds_read_b128 v[56:59], v13 offset:49152
  v_xor_b32 v10, 0x10000, v10
  v_xor_b32 v11, 0x10000, v11
  v_xor_b32 v12, 0x10000, v12
  v_xor_b32 v13, 0x10000, v13
  v_max3_f32 v16, v16, v176, v177
  v_max3_f32 v16, v16, v178, v179
  s_waitcnt lgkmcnt(3)
  v_mfma_f32_16x16x32_bf16 v[184:187], v[44:47], v[60:63], 0
  s_waitcnt lgkmcnt(2)
  v_mfma_f32_16x16x32_bf16 v[184:187], v[48:51], v[64:67], v[184:187]
  s_waitcnt lgkmcnt(1)
  v_mfma_f32_16x16x32_bf16 v[184:187], v[52:55], v[68:71], v[184:187]
  s_waitcnt lgkmcnt(0)
  v_mfma_f32_16x16x32_bf16 v[184:187], v[56:59], v[72:75], v[184:187]
  s_barrier
  ds_read_b128 v[44:47], v10 offset:0
  ds_read_b128 v[48:51], v11 offset:0
  ds_read_b128 v[52:55], v12 offset:0
  ds_read_b128 v[56:59], v13 offset:0
  v_max3_f32 v16, v16, v180, v181
  v_max3_f32 v16, v16, v182, v183
  s_waitcnt lgkmcnt(3)
  v_mfma_f32_16x16x32_bf16 v[188:191], v[44:47], v[60:63], 0
  s_waitcnt lgkmcnt(2)
  v_mfma_f32_16x16x32_bf16 v[188:191], v[48:51], v[64:67], v[188:191]
  s_waitcnt lgkmcnt(1)
  v_mfma_f32_16x16x32_bf16 v[188:191], v[52:55], v[68:71], v[188:191]
  s_waitcnt lgkmcnt(0)
  v_mfma_f32_16x16x32_bf16 v[188:191], v[56:59], v[72:75], v[188:191]
  s_barrier
  ds_read_b128 v[44:47], v10 offset:16384
  ds_read_b128 v[48:51], v11 offset:16384
  ds_read_b128 v[52:55], v12 offset:16384
  ds_read_b128 v[56:59], v13 offset:16384
  v_max3_f32 v16, v16, v184, v185
  v_max3_f32 v16, v16, v186, v187
  s_waitcnt lgkmcnt(3)
  v_mfma_f32_16x16x32_bf16 v[192:195], v[44:47], v[60:63], 0
  s_waitcnt lgkmcnt(2)
  v_mfma_f32_16x16x32_bf16 v[192:195], v[48:51], v[64:67], v[192:195]
  s_waitcnt lgkmcnt(1)
  v_mfma_f32_16x16x32_bf16 v[192:195], v[52:55], v[68:71], v[192:195]
  s_waitcnt lgkmcnt(0)
  v_mfma_f32_16x16x32_bf16 v[192:195], v[56:59], v[72:75], v[192:195]
  s_barrier
  ds_read_b128 v[44:47], v10 offset:32768
  ds_read_b128 v[48:51], v11 offset:32768
  ds_read_b128 v[52:55], v12 offset:32768
  ds_read_b128 v[56:59], v13 offset:32768
  v_max3_f32 v16, v16, v188, v189
  v_max3_f32 v16, v16, v190, v191
  s_waitcnt lgkmcnt(3)
  v_mfma_f32_16x16x32_bf16 v[196:199], v[44:47], v[60:63], 0
  s_waitcnt lgkmcnt(2)
  v_mfma_f32_16x16x32_bf16 v[196:199], v[48:51], v[64:67], v[196:199]
  s_waitcnt lgkmcnt(1)
  v_mfma_f32_16x16x32_bf16 v[196:199], v[52:55], v[68:71], v[196:199]
  s_waitcnt lgkmcnt(0)
  v_mfma_f32_16x16x32_bf16 v[196:199], v[56:59], v[72:75], v[196:199]
  s_barrier
  ds_read_b128 v[44:47], v10 offset:49152
  ds_read_b128 v[48:51], v11 offset:49152
  ds_read_b128 v[52:55], v12 offset:49152
  ds_read_b128 v[56:59], v13 offset:49152
  v_max3_f32 v16, v16, v192, v193
  v_max3_f32 v16, v16, v194, v195
  s_waitcnt lgkmcnt(3)
  v_mfma_f32_16x16x32_bf16 v[200:203], v[44:47], v[60:63], 0
  s_waitcnt lgkmcnt(2)
  v_mfma_f32_16x16x32_bf16 v[200:203], v[48:51], v[64:67], v[200:203]
  s_waitcnt lgkmcnt(1)
  v_mfma_f32_16x16x32_bf16 v[200:203], v[52:55], v[68:71], v[200:203]
  s_waitcnt lgkmcnt(0)
  v_mfma_f32_16x16x32_bf16 v[200:203], v[56:59], v[72:75], v[200:203]
  v_max3_f32 v16, v16, v196, v197
  v_max3_f32 v16, v16, v198, v199
  s_nop 5
  v_max3_f32 v16, v16, v200, v201
  v_max3_f32 v16, v16, v202, v203
  ds_write_b32 v6, v16 offset:16384
  s_waitcnt lgkmcnt(0)
  s_barrier
  ds_read_b128 v[28:31], v5 offset:16384
  s_waitcnt lgkmcnt(0)
  v_max3_f32 v16, v28, v29, v30
  v_max_f32 v16, v16, v31
  v_mov_b32 v1, v16
  s_nop 1
  v_permlane32_swap_b32 v16, v1
  s_nop 1
  v_max_f32 v16, v16, v1
  v_mov_b32 v1, v16
  s_nop 1
  v_permlane16_swap_b32 v16, v1
  s_nop 1
  v_max_f32 v16, v16, v1
  v_sub_f32 v76, v76, v16
  v_sub_f32 v77, v77, v16
  v_sub_f32 v78, v78, v16
  v_sub_f32 v79, v79, v16
  v_mul_f32 v76, s31, v76
  v_mul_f32 v77, s31, v77
  v_mul_f32 v78, s31, v78
  v_mul_f32 v79, s31, v79
  v_exp_f32 v76, v76
  v_exp_f32 v77, v77
  v_exp_f32 v78, v78
  v_exp_f32 v79, v79
  v_add_f32 v17, v76, v77
  v_add_f32 v17, v17, v78
  v_add_f32 v17, v17, v79
  v_cvt_pk_bf16_f32 v76, v76, v77
  v_cvt_pk_bf16_f32 v77, v78, v79
  ds_write_b64 v4, v[76:77] offset:0
  v_sub_f32 v80, v80, v16
  v_sub_f32 v81, v81, v16
  v_sub_f32 v82, v82, v16
  v_sub_f32 v83, v83, v16
  v_mul_f32 v80, s31, v80
  v_mul_f32 v81, s31, v81
  v_mul_f32 v82, s31, v82
  v_mul_f32 v83, s31, v83
  v_exp_f32 v80, v80
  v_exp_f32 v81, v81
  v_exp_f32 v82, v82
  v_exp_f32 v83, v83
  v_add_f32 v17, v17, v80
  v_add_f32 v17, v17, v81
  v_add_f32 v17, v17, v82
  v_add_f32 v17, v17, v83
  v_cvt_pk_bf16_f32 v80, v80, v81
  v_cvt_pk_bf16_f32 v81, v82, v83
  ds_write_b64 v4, v[80:81] offset:2048
  v_sub_f32 v84, v84, v16
  v_sub_f32 v85, v85, v16
  v_sub_f32 v86, v86, v16
  v_sub_f32 v87, v87, v16
  v_mul_f32 v84, s31, v84
  v_mul_f32 v85, s31, v85
  v_mul_f32 v86, s31, v86
  v_mul_f32 v87, s31, v87
  v_exp_f32 v84, v84
  v_exp_f32 v85, v85
  v_exp_f32 v86, v86
  v_exp_f32 v87, v87
  v_add_f32 v17, v17, v84
  v_add_f32 v17, v17, v85
  v_add_f32 v17, v17, v86
  v_add_f32 v17, v17, v87
  v_cvt_pk_bf16_f32 v84, v84, v85
  v_cvt_pk_bf16_f32 v85, v86, v87
  ds_write_b64 v4, v[84:85] offset:4096
  s_waitcnt lgkmcnt(0)
  s_barrier
  ds_read_b128 v[28:31], v5 offset:0
  ds_read_b128 v[32:35], v5 offset:1024
  ds_read_b64_tr_b16 v[44:45], v14 offset:0
  ds_read_b64_tr_b16 v[46:47], v14 offset:4096
  ds_read_b64_tr_b16 v[48:49], v15 offset:0
  ds_read_b64_tr_b16 v[50:51], v15 offset:4096
  ds_read_b64_tr_b16 v[52:53], v14 offset:8192
  ds_read_b64_tr_b16 v[54:55], v14 offset:12288
  ds_read_b64_tr_b16 v[56:57], v15 offset:8192
  ds_read_b64_tr_b16 v[58:59], v15 offset:12288
  s_waitcnt lgkmcnt(9)
  s_waitcnt lgkmcnt(6)
  v_mfma_f32_16x16x32_bf16 v[20:23], v[44:47], v[28:31], 0
  s_waitcnt lgkmcnt(4)
  v_mfma_f32_16x16x32_bf16 v[24:27], v[48:51], v[28:31], 0
  s_waitcnt lgkmcnt(2)
  v_mfma_f32_16x16x32_bf16 v[20:23], v[52:55], v[32:35], v[20:23]
  s_waitcnt lgkmcnt(0)
  v_mfma_f32_16x16x32_bf16 v[24:27], v[56:59], v[32:35], v[24:27]
  ds_read_b128 v[36:39], v5 offset:2048
  ds_read_b128 v[40:43], v5 offset:3072
  ds_read_b64_tr_b16 v[60:61], v14 offset:16384
  ds_read_b64_tr_b16 v[62:63], v14 offset:20480
  ds_read_b64_tr_b16 v[64:65], v15 offset:16384
  ds_read_b64_tr_b16 v[66:67], v15 offset:20480
  ds_read_b64_tr_b16 v[68:69], v14 offset:24576
  ds_read_b64_tr_b16 v[70:71], v14 offset:28672
  ds_read_b64_tr_b16 v[72:73], v15 offset:24576
  ds_read_b64_tr_b16 v[74:75], v15 offset:28672
  s_waitcnt lgkmcnt(9)
  s_waitcnt lgkmcnt(6)
  v_mfma_f32_16x16x32_bf16 v[20:23], v[60:63], v[36:39], v[20:23]
  s_waitcnt lgkmcnt(4)
  v_mfma_f32_16x16x32_bf16 v[24:27], v[64:67], v[36:39], v[24:27]
  s_waitcnt lgkmcnt(2)
  v_mfma_f32_16x16x32_bf16 v[20:23], v[68:71], v[40:43], v[20:23]
  s_waitcnt lgkmcnt(0)
  v_mfma_f32_16x16x32_bf16 v[24:27], v[72:75], v[40:43], v[24:27]
  ds_read_b128 v[28:31], v5 offset:4096
  ds_read_b128 v[32:35], v5 offset:5120
  v_sub_f32 v88, v88, v16
  v_sub_f32 v89, v89, v16
  v_sub_f32 v90, v90, v16
  v_sub_f32 v91, v91, v16
  v_mul_f32 v88, s31, v88
  v_mul_f32 v89, s31, v89
  v_mul_f32 v90, s31, v90
  v_mul_f32 v91, s31, v91
  v_exp_f32 v88, v88
  v_exp_f32 v89, v89
  v_exp_f32 v90, v90
  v_exp_f32 v91, v91
  v_add_f32 v17, v17, v88
  v_add_f32 v17, v17, v89
  v_add_f32 v17, v17, v90
  v_add_f32 v17, v17, v91
  v_cvt_pk_bf16_f32 v88, v88, v89
  v_cvt_pk_bf16_f32 v89, v90, v91
  ds_write_b64 v4, v[88:89] offset:6144
  v_sub_f32 v92, v92, v16
  v_sub_f32 v93, v93, v16
  v_sub_f32 v94, v94, v16
  v_sub_f32 v95, v95, v16
  v_mul_f32 v92, s31, v92
  v_mul_f32 v93, s31, v93
  v_mul_f32 v94, s31, v94
  v_mul_f32 v95, s31, v95
  v_exp_f32 v92, v92
  v_exp_f32 v93, v93
  v_exp_f32 v94, v94
  v_exp_f32 v95, v95
  v_add_f32 v17, v17, v92
  v_add_f32 v17, v17, v93
  v_add_f32 v17, v17, v94
  v_add_f32 v17, v17, v95
  v_cvt_pk_bf16_f32 v92, v92, v93
  v_cvt_pk_bf16_f32 v93, v94, v95
  ds_write_b64 v4, v[92:93] offset:8192
  s_waitcnt lgkmcnt(0)
  s_barrier
  ds_read_b64_tr_b16 v[44:45], v14 offset:32768
  ds_read_b64_tr_b16 v[46:47], v14 offset:36864
  ds_read_b64_tr_b16 v[48:49], v15 offset:32768
  ds_read_b64_tr_b16 v[50:51], v15 offset:36864
  ds_read_b64_tr_b16 v[52:53], v14 offset:40960
  ds_read_b64_tr_b16 v[54:55], v14 offset:45056
  ds_read_b64_tr_b16 v[56:57], v15 offset:40960
  ds_read_b64_tr_b16 v[58:59], v15 offset:45056
  ds_read_b128 v[36:39], v5 offset:6144
  ds_read_b128 v[40:43], v5 offset:7168
  s_waitcnt lgkmcnt(8)
  v_mfma_f32_16x16x32_bf16 v[20:23], v[44:47], v[28:31], v[20:23]
  s_waitcnt lgkmcnt(6)
  v_mfma_f32_16x16x32_bf16 v[24:27], v[48:51], v[28:31], v[24:27]
  s_waitcnt lgkmcnt(4)
  v_mfma_f32_16x16x32_bf16 v[20:23], v[52:55], v[32:35], v[20:23]
  s_waitcnt lgkmcnt(2)
  v_mfma_f32_16x16x32_bf16 v[24:27], v[56:59], v[32:35], v[24:27]
  v_sub_f32 v96, v96, v16
  v_sub_f32 v97, v97, v16
  v_sub_f32 v98, v98, v16
  v_sub_f32 v99, v99, v16
  v_mul_f32 v96, s31, v96
  v_mul_f32 v97, s31, v97
  v_mul_f32 v98, s31, v98
  v_mul_f32 v99, s31, v99
  v_exp_f32 v96, v96
  v_exp_f32 v97, v97
  v_exp_f32 v98, v98
  v_exp_f32 v99, v99
  v_add_f32 v17, v17, v96
  v_add_f32 v17, v17, v97
  v_add_f32 v17, v17, v98
  v_add_f32 v17, v17, v99
  v_cvt_pk_bf16_f32 v96, v96, v97
  v_cvt_pk_bf16_f32 v97, v98, v99
  ds_write_b64 v4, v[96:97] offset:10240
  v_sub_f32 v100, v100, v16
  v_sub_f32 v101, v101, v16
  v_sub_f32 v102, v102, v16
  v_sub_f32 v103, v103, v16
  v_mul_f32 v100, s31, v100
  v_mul_f32 v101, s31, v101
  v_mul_f32 v102, s31, v102
  v_mul_f32 v103, s31, v103
  v_exp_f32 v100, v100
  v_exp_f32 v101, v101
  v_exp_f32 v102, v102
  v_exp_f32 v103, v103
  v_add_f32 v17, v17, v100
  v_add_f32 v17, v17, v101
  v_add_f32 v17, v17, v102
  v_add_f32 v17, v17, v103
  v_cvt_pk_bf16_f32 v100, v100, v101
  v_cvt_pk_bf16_f32 v101, v102, v103
  ds_write_b64 v4, v[100:101] offset:12288
  s_waitcnt lgkmcnt(0)
  s_barrier
  ds_read_b64_tr_b16 v[60:61], v14 offset:49152
  ds_read_b64_tr_b16 v[62:63], v14 offset:53248
  ds_read_b64_tr_b16 v[64:65], v15 offset:49152
  ds_read_b64_tr_b16 v[66:67], v15 offset:53248
  ds_read_b64_tr_b16 v[68:69], v14 offset:57344
  ds_read_b64_tr_b16 v[70:71], v14 offset:61440
  ds_read_b64_tr_b16 v[72:73], v15 offset:57344
  ds_read_b64_tr_b16 v[74:75], v15 offset:61440
  v_xor_b32 v14, 0x10000, v14
  v_xor_b32 v15, 0x10000, v15
  ds_read_b128 v[28:31], v5 offset:8192
  ds_read_b128 v[32:35], v5 offset:9216
  s_waitcnt lgkmcnt(8)
  v_mfma_f32_16x16x32_bf16 v[20:23], v[60:63], v[36:39], v[20:23]
  s_waitcnt lgkmcnt(6)
  v_mfma_f32_16x16x32_bf16 v[24:27], v[64:67], v[36:39], v[24:27]
  s_waitcnt lgkmcnt(4)
  v_mfma_f32_16x16x32_bf16 v[20:23], v[68:71], v[40:43], v[20:23]
  s_waitcnt lgkmcnt(2)
  v_mfma_f32_16x16x32_bf16 v[24:27], v[72:75], v[40:43], v[24:27]
  v_sub_f32 v104, v104, v16
  v_sub_f32 v105, v105, v16
  v_sub_f32 v106, v106, v16
  v_sub_f32 v107, v107, v16
  v_mul_f32 v104, s31, v104
  v_mul_f32 v105, s31, v105
  v_mul_f32 v106, s31, v106
  v_mul_f32 v107, s31, v107
  v_exp_f32 v104, v104
  v_exp_f32 v105, v105
  v_exp_f32 v106, v106
  v_exp_f32 v107, v107
  v_add_f32 v17, v17, v104
  v_add_f32 v17, v17, v105
  v_add_f32 v17, v17, v106
  v_add_f32 v17, v17, v107
  v_cvt_pk_bf16_f32 v104, v104, v105
  v_cvt_pk_bf16_f32 v105, v106, v107
  ds_write_b64 v4, v[104:105] offset:14336
  v_sub_f32 v108, v108, v16
  v_sub_f32 v109, v109, v16
  v_sub_f32 v110, v110, v16
  v_sub_f32 v111, v111, v16
  v_mul_f32 v108, s31, v108
  v_mul_f32 v109, s31, v109
  v_mul_f32 v110, s31, v110
  v_mul_f32 v111, s31, v111
  v_exp_f32 v108, v108
  v_exp_f32 v109, v109
  v_exp_f32 v110, v110
  v_exp_f32 v111, v111
  v_add_f32 v17, v17, v108
  v_add_f32 v17, v17, v109
  v_add_f32 v17, v17, v110
  v_add_f32 v17, v17, v111
  v_cvt_pk_bf16_f32 v108, v108, v109
  v_cvt_pk_bf16_f32 v109, v110, v111
  ds_write_b64 v4, v[108:109] offset:0
  s_waitcnt lgkmcnt(0)
  s_barrier
  ds_read_b64_tr_b16 v[44:45], v14 offset:0
  ds_read_b64_tr_b16 v[46:47], v14 offset:4096
  ds_read_b64_tr_b16 v[48:49], v15 offset:0
  ds_read_b64_tr_b16 v[50:51], v15 offset:4096
  ds_read_b64_tr_b16 v[52:53], v14 offset:8192
  ds_read_b64_tr_b16 v[54:55], v14 offset:12288
  ds_read_b64_tr_b16 v[56:57], v15 offset:8192
  ds_read_b64_tr_b16 v[58:59], v15 offset:12288
  ds_read_b128 v[36:39], v5 offset:10240
  ds_read_b128 v[40:43], v5 offset:11264
  s_waitcnt lgkmcnt(8)
  v_mfma_f32_16x16x32_bf16 v[20:23], v[44:47], v[28:31], v[20:23]
  s_waitcnt lgkmcnt(6)
  v_mfma_f32_16x16x32_bf16 v[24:27], v[48:51], v[28:31], v[24:27]
  s_waitcnt lgkmcnt(4)
  v_mfma_f32_16x16x32_bf16 v[20:23], v[52:55], v[32:35], v[20:23]
  s_waitcnt lgkmcnt(2)
  v_mfma_f32_16x16x32_bf16 v[24:27], v[56:59], v[32:35], v[24:27]
  v_sub_f32 v112, v112, v16
  v_sub_f32 v113, v113, v16
  v_sub_f32 v114, v114, v16
  v_sub_f32 v115, v115, v16
  v_mul_f32 v112, s31, v112
  v_mul_f32 v113, s31, v113
  v_mul_f32 v114, s31, v114
  v_mul_f32 v115, s31, v115
  v_exp_f32 v112, v112
  v_exp_f32 v113, v113
  v_exp_f32 v114, v114
  v_exp_f32 v115, v115
  v_add_f32 v17, v17, v112
  v_add_f32 v17, v17, v113
  v_add_f32 v17, v17, v114
  v_add_f32 v17, v17, v115
  v_cvt_pk_bf16_f32 v112, v112, v113
  v_cvt_pk_bf16_f32 v113, v114, v115
  ds_write_b64 v4, v[112:113] offset:2048
  v_sub_f32 v116, v116, v16
  v_sub_f32 v117, v117, v16
  v_sub_f32 v118, v118, v16
  v_sub_f32 v119, v119, v16
  v_mul_f32 v116, s31, v116
  v_mul_f32 v117, s31, v117
  v_mul_f32 v118, s31, v118
  v_mul_f32 v119, s31, v119
  v_exp_f32 v116, v116
  v_exp_f32 v117, v117
  v_exp_f32 v118, v118
  v_exp_f32 v119, v119
  v_add_f32 v17, v17, v116
  v_add_f32 v17, v17, v117
  v_add_f32 v17, v17, v118
  v_add_f32 v17, v17, v119
  v_cvt_pk_bf16_f32 v116, v116, v117
  v_cvt_pk_bf16_f32 v117, v118, v119
  ds_write_b64 v4, v[116:117] offset:4096
  s_waitcnt lgkmcnt(0)
  s_barrier
  ds_read_b64_tr_b16 v[60:61], v14 offset:16384
  ds_read_b64_tr_b16 v[62:63], v14 offset:20480
  ds_read_b64_tr_b16 v[64:65], v15 offset:16384
  ds_read_b64_tr_b16 v[66:67], v15 offset:20480
  ds_read_b64_tr_b16 v[68:69], v14 offset:24576
  ds_read_b64_tr_b16 v[70:71], v14 offset:28672
  ds_read_b64_tr_b16 v[72:73], v15 offset:24576
  ds_read_b64_tr_b16 v[74:75], v15 offset:28672
  ds_read_b128 v[28:31], v5 offset:12288
  ds_read_b128 v[32:35], v5 offset:13312
  s_waitcnt lgkmcnt(8)
  v_mfma_f32_16x16x32_bf16 v[20:23], v[60:63], v[36:39], v[20:23]
  s_waitcnt lgkmcnt(6)
  v_mfma_f32_16x16x32_bf16 v[24:27], v[64:67], v[36:39], v[24:27]
  s_waitcnt lgkmcnt(4)
  v_mfma_f32_16x16x32_bf16 v[20:23], v[68:71], v[40:43], v[20:23]
  s_waitcnt lgkmcnt(2)
  v_mfma_f32_16x16x32_bf16 v[24:27], v[72:75], v[40:43], v[24:27]
  v_sub_f32 v120, v120, v16
  v_sub_f32 v121, v121, v16
  v_sub_f32 v122, v122, v16
  v_sub_f32 v123, v123, v16
  v_mul_f32 v120, s31, v120
  v_mul_f32 v121, s31, v121
  v_mul_f32 v122, s31, v122
  v_mul_f32 v123, s31, v123
  v_exp_f32 v120, v120
  v_exp_f32 v121, v121
  v_exp_f32 v122, v122
  v_exp_f32 v123, v123
  v_add_f32 v17, v17, v120
  v_add_f32 v17, v17, v121
  v_add_f32 v17, v17, v122
  v_add_f32 v17, v17, v123
  v_cvt_pk_bf16_f32 v120, v120, v121
  v_cvt_pk_bf16_f32 v121, v122, v123
  ds_write_b64 v4, v[120:121] offset:6144
  s_waitcnt lgkmcnt(0)
  s_barrier
  ds_read_b64_tr_b16 v[44:45], v14 offset:32768
  ds_read_b64_tr_b16 v[46:47], v14 offset:36864
  ds_read_b64_tr_b16 v[48:49], v15 offset:32768
  ds_read_b64_tr_b16 v[50:51], v15 offset:36864
  ds_read_b64_tr_b16 v[52:53], v14 offset:40960
  ds_read_b64_tr_b16 v[54:55], v14 offset:45056
  ds_read_b64_tr_b16 v[56:57], v15 offset:40960
  ds_read_b64_tr_b16 v[58:59], v15 offset:45056
  ds_read_b128 v[36:39], v5 offset:14336
  ds_read_b128 v[40:43], v5 offset:15360
  s_waitcnt lgkmcnt(8)
  v_mfma_f32_16x16x32_bf16 v[20:23], v[44:47], v[28:31], v[20:23]
  s_waitcnt lgkmcnt(6)
  v_mfma_f32_16x16x32_bf16 v[24:27], v[48:51], v[28:31], v[24:27]
  s_waitcnt lgkmcnt(4)
  v_mfma_f32_16x16x32_bf16 v[20:23], v[52:55], v[32:35], v[20:23]
  s_waitcnt lgkmcnt(2)
  v_mfma_f32_16x16x32_bf16 v[24:27], v[56:59], v[32:35], v[24:27]
  v_sub_f32 v124, v124, v16
  v_sub_f32 v125, v125, v16
  v_sub_f32 v126, v126, v16
  v_sub_f32 v127, v127, v16
  v_mul_f32 v124, s31, v124
  v_mul_f32 v125, s31, v125
  v_mul_f32 v126, s31, v126
  v_mul_f32 v127, s31, v127
  v_exp_f32 v124, v124
  v_exp_f32 v125, v125
  v_exp_f32 v126, v126
  v_exp_f32 v127, v127
  v_add_f32 v17, v17, v124
  v_add_f32 v17, v17, v125
  v_add_f32 v17, v17, v126
  v_add_f32 v17, v17, v127
  v_cvt_pk_bf16_f32 v124, v124, v125
  v_cvt_pk_bf16_f32 v125, v126, v127
  ds_write_b64 v4, v[124:125] offset:8192
  s_waitcnt lgkmcnt(0)
  s_barrier
  ds_read_b64_tr_b16 v[60:61], v14 offset:49152
  ds_read_b64_tr_b16 v[62:63], v14 offset:53248
  ds_read_b64_tr_b16 v[64:65], v15 offset:49152
  ds_read_b64_tr_b16 v[66:67], v15 offset:53248
  ds_read_b64_tr_b16 v[68:69], v14 offset:57344
  ds_read_b64_tr_b16 v[70:71], v14 offset:61440
  ds_read_b64_tr_b16 v[72:73], v15 offset:57344
  ds_read_b64_tr_b16 v[74:75], v15 offset:61440
  v_xor_b32 v14, 0x10000, v14
  v_xor_b32 v15, 0x10000, v15
  ds_read_b128 v[28:31], v5 offset:0
  ds_read_b128 v[32:35], v5 offset:1024
  s_waitcnt lgkmcnt(8)
  v_mfma_f32_16x16x32_bf16 v[20:23], v[60:63], v[36:39], v[20:23]
  s_waitcnt lgkmcnt(6)
  v_mfma_f32_16x16x32_bf16 v[24:27], v[64:67], v[36:39], v[24:27]
  s_waitcnt lgkmcnt(4)
  v_mfma_f32_16x16x32_bf16 v[20:23], v[68:71], v[40:43], v[20:23]
  s_waitcnt lgkmcnt(2)
  v_mfma_f32_16x16x32_bf16 v[24:27], v[72:75], v[40:43], v[24:27]
  v_sub_f32 v128, v128, v16
  v_sub_f32 v129, v129, v16
  v_sub_f32 v130, v130, v16
  v_sub_f32 v131, v131, v16
  v_mul_f32 v128, s31, v128
  v_mul_f32 v129, s31, v129
  v_mul_f32 v130, s31, v130
  v_mul_f32 v131, s31, v131
  v_exp_f32 v128, v128
  v_exp_f32 v129, v129
  v_exp_f32 v130, v130
  v_exp_f32 v131, v131
  v_add_f32 v17, v17, v128
  v_add_f32 v17, v17, v129
  v_add_f32 v17, v17, v130
  v_add_f32 v17, v17, v131
  v_cvt_pk_bf16_f32 v128, v128, v129
  v_cvt_pk_bf16_f32 v129, v130, v131
  ds_write_b64 v4, v[128:129] offset:10240
  s_waitcnt lgkmcnt(0)
  s_barrier
  ds_read_b64_tr_b16 v[44:45], v14 offset:0
  ds_read_b64_tr_b16 v[46:47], v14 offset:4096
  ds_read_b64_tr_b16 v[48:49], v15 offset:0
  ds_read_b64_tr_b16 v[50:51], v15 offset:4096
  ds_read_b64_tr_b16 v[52:53], v14 offset:8192
  ds_read_b64_tr_b16 v[54:55], v14 offset:12288
  ds_read_b64_tr_b16 v[56:57], v15 offset:8192
  ds_read_b64_tr_b16 v[58:59], v15 offset:12288
  ds_read_b128 v[36:39], v5 offset:2048
  ds_read_b128 v[40:43], v5 offset:3072
  s_waitcnt lgkmcnt(8)
  v_mfma_f32_16x16x32_bf16 v[20:23], v[44:47], v[28:31], v[20:23]
  s_waitcnt lgkmcnt(6)
  v_mfma_f32_16x16x32_bf16 v[24:27], v[48:51], v[28:31], v[24:27]
  s_waitcnt lgkmcnt(4)
  v_mfma_f32_16x16x32_bf16 v[20:23], v[52:55], v[32:35], v[20:23]
  s_waitcnt lgkmcnt(2)
  v_mfma_f32_16x16x32_bf16 v[24:27], v[56:59], v[32:35], v[24:27]
  v_sub_f32 v132, v132, v16
  v_sub_f32 v133, v133, v16
  v_sub_f32 v134, v134, v16
  v_sub_f32 v135, v135, v16
  v_mul_f32 v132, s31, v132
  v_mul_f32 v133, s31, v133
  v_mul_f32 v134, s31, v134
  v_mul_f32 v135, s31, v135
  v_exp_f32 v132, v132
  v_exp_f32 v133, v133
  v_exp_f32 v134, v134
  v_exp_f32 v135, v135
  v_add_f32 v17, v17, v132
  v_add_f32 v17, v17, v133
  v_add_f32 v17, v17, v134
  v_add_f32 v17, v17, v135
  v_cvt_pk_bf16_f32 v132, v132, v133
  v_cvt_pk_bf16_f32 v133, v134, v135
  ds_write_b64 v4, v[132:133] offset:12288
  s_waitcnt lgkmcnt(0)
  s_barrier
  ds_read_b64_tr_b16 v[60:61], v14 offset:16384
  ds_read_b64_tr_b16 v[62:63], v14 offset:20480
  ds_read_b64_tr_b16 v[64:65], v15 offset:16384
  ds_read_b64_tr_b16 v[66:67], v15 offset:20480
  ds_read_b64_tr_b16 v[68:69], v14 offset:24576
  ds_read_b64_tr_b16 v[70:71], v14 offset:28672
  ds_read_b64_tr_b16 v[72:73], v15 offset:24576
  ds_read_b64_tr_b16 v[74:75], v15 offset:28672
  ds_read_b128 v[28:31], v5 offset:4096
  ds_read_b128 v[32:35], v5 offset:5120
  s_waitcnt lgkmcnt(8)
  v_mfma_f32_16x16x32_bf16 v[20:23], v[60:63], v[36:39], v[20:23]
  s_waitcnt lgkmcnt(6)
  v_mfma_f32_16x16x32_bf16 v[24:27], v[64:67], v[36:39], v[24:27]
  s_waitcnt lgkmcnt(4)
  v_mfma_f32_16x16x32_bf16 v[20:23], v[68:71], v[40:43], v[20:23]
  s_waitcnt lgkmcnt(2)
  v_mfma_f32_16x16x32_bf16 v[24:27], v[72:75], v[40:43], v[24:27]
  v_sub_f32 v136, v136, v16
  v_sub_f32 v137, v137, v16
  v_sub_f32 v138, v138, v16
  v_sub_f32 v139, v139, v16
  v_mul_f32 v136, s31, v136
  v_mul_f32 v137, s31, v137
  v_mul_f32 v138, s31, v138
  v_mul_f32 v139, s31, v139
  v_exp_f32 v136, v136
  v_exp_f32 v137, v137
  v_exp_f32 v138, v138
  v_exp_f32 v139, v139
  v_add_f32 v17, v17, v136
  v_add_f32 v17, v17, v137
  v_add_f32 v17, v17, v138
  v_add_f32 v17, v17, v139
  v_cvt_pk_bf16_f32 v136, v136, v137
  v_cvt_pk_bf16_f32 v137, v138, v139
  ds_write_b64 v4, v[136:137] offset:14336
  s_waitcnt lgkmcnt(0)
  s_barrier
  ds_read_b64_tr_b16 v[44:45], v14 offset:32768
  ds_read_b64_tr_b16 v[46:47], v14 offset:36864
  ds_read_b64_tr_b16 v[48:49], v15 offset:32768
  ds_read_b64_tr_b16 v[50:51], v15 offset:36864
  ds_read_b64_tr_b16 v[52:53], v14 offset:40960
  ds_read_b64_tr_b16 v[54:55], v14 offset:45056
  ds_read_b64_tr_b16 v[56:57], v15 offset:40960
  ds_read_b64_tr_b16 v[58:59], v15 offset:45056
  ds_read_b128 v[36:39], v5 offset:6144
  ds_read_b128 v[40:43], v5 offset:7168
  s_waitcnt lgkmcnt(8)
  v_mfma_f32_16x16x32_bf16 v[20:23], v[44:47], v[28:31], v[20:23]
  s_waitcnt lgkmcnt(6)
  v_mfma_f32_16x16x32_bf16 v[24:27], v[48:51], v[28:31], v[24:27]
  s_waitcnt lgkmcnt(4)
  v_mfma_f32_16x16x32_bf16 v[20:23], v[52:55], v[32:35], v[20:23]
  s_waitcnt lgkmcnt(2)
  v_mfma_f32_16x16x32_bf16 v[24:27], v[56:59], v[32:35], v[24:27]
  v_sub_f32 v140, v140, v16
  v_sub_f32 v141, v141, v16
  v_sub_f32 v142, v142, v16
  v_sub_f32 v143, v143, v16
  v_mul_f32 v140, s31, v140
  v_mul_f32 v141, s31, v141
  v_mul_f32 v142, s31, v142
  v_mul_f32 v143, s31, v143
  v_exp_f32 v140, v140
  v_exp_f32 v141, v141
  v_exp_f32 v142, v142
  v_exp_f32 v143, v143
  v_add_f32 v17, v17, v140
  v_add_f32 v17, v17, v141
  v_add_f32 v17, v17, v142
  v_add_f32 v17, v17, v143
  v_cvt_pk_bf16_f32 v140, v140, v141
  v_cvt_pk_bf16_f32 v141, v142, v143
  ds_write_b64 v4, v[140:141] offset:0
  s_waitcnt lgkmcnt(0)
  s_barrier
  ds_read_b64_tr_b16 v[60:61], v14 offset:49152
  ds_read_b64_tr_b16 v[62:63], v14 offset:53248
  ds_read_b64_tr_b16 v[64:65], v15 offset:49152
  ds_read_b64_tr_b16 v[66:67], v15 offset:53248
  ds_read_b64_tr_b16 v[68:69], v14 offset:57344
  ds_read_b64_tr_b16 v[70:71], v14 offset:61440
  ds_read_b64_tr_b16 v[72:73], v15 offset:57344
  ds_read_b64_tr_b16 v[74:75], v15 offset:61440
  v_xor_b32 v14, 0x10000, v14
  v_xor_b32 v15, 0x10000, v15
  ds_read_b128 v[28:31], v5 offset:8192
  ds_read_b128 v[32:35], v5 offset:9216
  s_waitcnt lgkmcnt(8)
  v_mfma_f32_16x16x32_bf16 v[20:23], v[60:63], v[36:39], v[20:23]
  s_waitcnt lgkmcnt(6)
  v_mfma_f32_16x16x32_bf16 v[24:27], v[64:67], v[36:39], v[24:27]
  s_waitcnt lgkmcnt(4)
  v_mfma_f32_16x16x32_bf16 v[20:23], v[68:71], v[40:43], v[20:23]
  s_waitcnt lgkmcnt(2)
  v_mfma_f32_16x16x32_bf16 v[24:27], v[72:75], v[40:43], v[24:27]
  v_sub_f32 v144, v144, v16
  v_sub_f32 v145, v145, v16
  v_sub_f32 v146, v146, v16
  v_sub_f32 v147, v147, v16
  v_mul_f32 v144, s31, v144
  v_mul_f32 v145, s31, v145
  v_mul_f32 v146, s31, v146
  v_mul_f32 v147, s31, v147
  v_exp_f32 v144, v144
  v_exp_f32 v145, v145
  v_exp_f32 v146, v146
  v_exp_f32 v147, v147
  v_add_f32 v17, v17, v144
  v_add_f32 v17, v17, v145
  v_add_f32 v17, v17, v146
  v_add_f32 v17, v17, v147
  v_cvt_pk_bf16_f32 v144, v144, v145
  v_cvt_pk_bf16_f32 v145, v146, v147
  ds_write_b64 v4, v[144:145] offset:2048
  s_waitcnt lgkmcnt(0)
  s_barrier
  ds_read_b64_tr_b16 v[44:45], v14 offset:0
  ds_read_b64_tr_b16 v[46:47], v14 offset:4096
  ds_read_b64_tr_b16 v[48:49], v15 offset:0
  ds_read_b64_tr_b16 v[50:51], v15 offset:4096
  ds_read_b64_tr_b16 v[52:53], v14 offset:8192
  ds_read_b64_tr_b16 v[54:55], v14 offset:12288
  ds_read_b64_tr_b16 v[56:57], v15 offset:8192
  ds_read_b64_tr_b16 v[58:59], v15 offset:12288
  ds_read_b128 v[36:39], v5 offset:10240
  ds_read_b128 v[40:43], v5 offset:11264
  s_waitcnt lgkmcnt(8)
  v_mfma_f32_16x16x32_bf16 v[20:23], v[44:47], v[28:31], v[20:23]
  s_waitcnt lgkmcnt(6)
  v_mfma_f32_16x16x32_bf16 v[24:27], v[48:51], v[28:31], v[24:27]
  s_waitcnt lgkmcnt(4)
  v_mfma_f32_16x16x32_bf16 v[20:23], v[52:55], v[32:35], v[20:23]
  s_waitcnt lgkmcnt(2)
  v_mfma_f32_16x16x32_bf16 v[24:27], v[56:59], v[32:35], v[24:27]
  v_sub_f32 v148, v148, v16
  v_sub_f32 v149, v149, v16
  v_sub_f32 v150, v150, v16
  v_sub_f32 v151, v151, v16
  v_mul_f32 v148, s31, v148
  v_mul_f32 v149, s31, v149
  v_mul_f32 v150, s31, v150
  v_mul_f32 v151, s31, v151
  v_exp_f32 v148, v148
  v_exp_f32 v149, v149
  v_exp_f32 v150, v150
  v_exp_f32 v151, v151
  v_add_f32 v17, v17, v148
  v_add_f32 v17, v17, v149
  v_add_f32 v17, v17, v150
  v_add_f32 v17, v17, v151
  v_cvt_pk_bf16_f32 v148, v148, v149
  v_cvt_pk_bf16_f32 v149, v150, v151
  ds_write_b64 v4, v[148:149] offset:4096
  s_waitcnt lgkmcnt(0)
  s_barrier
  ds_read_b64_tr_b16 v[60:61], v14 offset:16384
  ds_read_b64_tr_b16 v[62:63], v14 offset:20480
  ds_read_b64_tr_b16 v[64:65], v15 offset:16384
  ds_read_b64_tr_b16 v[66:67], v15 offset:20480
  ds_read_b64_tr_b16 v[68:69], v14 offset:24576
  ds_read_b64_tr_b16 v[70:71], v14 offset:28672
  ds_read_b64_tr_b16 v[72:73], v15 offset:24576
  ds_read_b64_tr_b16 v[74:75], v15 offset:28672
  ds_read_b128 v[28:31], v5 offset:12288
  ds_read_b128 v[32:35], v5 offset:13312
  s_waitcnt lgkmcnt(8)
  v_mfma_f32_16x16x32_bf16 v[20:23], v[60:63], v[36:39], v[20:23]
  s_waitcnt lgkmcnt(6)
  v_mfma_f32_16x16x32_bf16 v[24:27], v[64:67], v[36:39], v[24:27]
  s_waitcnt lgkmcnt(4)
  v_mfma_f32_16x16x32_bf16 v[20:23], v[68:71], v[40:43], v[20:23]
  s_waitcnt lgkmcnt(2)
  v_mfma_f32_16x16x32_bf16 v[24:27], v[72:75], v[40:43], v[24:27]
  v_sub_f32 v152, v152, v16
  v_sub_f32 v153, v153, v16
  v_sub_f32 v154, v154, v16
  v_sub_f32 v155, v155, v16
  v_mul_f32 v152, s31, v152
  v_mul_f32 v153, s31, v153
  v_mul_f32 v154, s31, v154
  v_mul_f32 v155, s31, v155
  v_exp_f32 v152, v152
  v_exp_f32 v153, v153
  v_exp_f32 v154, v154
  v_exp_f32 v155, v155
  v_add_f32 v17, v17, v152
  v_add_f32 v17, v17, v153
  v_add_f32 v17, v17, v154
  v_add_f32 v17, v17, v155
  v_cvt_pk_bf16_f32 v152, v152, v153
  v_cvt_pk_bf16_f32 v153, v154, v155
  ds_write_b64 v4, v[152:153] offset:6144
  s_waitcnt lgkmcnt(0)
  s_barrier
  ds_read_b64_tr_b16 v[44:45], v14 offset:32768
  ds_read_b64_tr_b16 v[46:47], v14 offset:36864
  ds_read_b64_tr_b16 v[48:49], v15 offset:32768
  ds_read_b64_tr_b16 v[50:51], v15 offset:36864
  ds_read_b64_tr_b16 v[52:53], v14 offset:40960
  ds_read_b64_tr_b16 v[54:55], v14 offset:45056
  ds_read_b64_tr_b16 v[56:57], v15 offset:40960
  ds_read_b64_tr_b16 v[58:59], v15 offset:45056
  ds_read_b128 v[36:39], v5 offset:14336
  ds_read_b128 v[40:43], v5 offset:15360
  s_waitcnt lgkmcnt(8)
  v_mfma_f32_16x16x32_bf16 v[20:23], v[44:47], v[28:31], v[20:23]
  s_waitcnt lgkmcnt(6)
  v_mfma_f32_16x16x32_bf16 v[24:27], v[48:51], v[28:31], v[24:27]
  s_waitcnt lgkmcnt(4)
  v_mfma_f32_16x16x32_bf16 v[20:23], v[52:55], v[32:35], v[20:23]
  s_waitcnt lgkmcnt(2)
  v_mfma_f32_16x16x32_bf16 v[24:27], v[56:59], v[32:35], v[24:27]
  v_sub_f32 v156, v156, v16
  v_sub_f32 v157, v157, v16
  v_sub_f32 v158, v158, v16
  v_sub_f32 v159, v159, v16
  v_mul_f32 v156, s31, v156
  v_mul_f32 v157, s31, v157
  v_mul_f32 v158, s31, v158
  v_mul_f32 v159, s31, v159
  v_exp_f32 v156, v156
  v_exp_f32 v157, v157
  v_exp_f32 v158, v158
  v_exp_f32 v159, v159
  v_add_f32 v17, v17, v156
  v_add_f32 v17, v17, v157
  v_add_f32 v17, v17, v158
  v_add_f32 v17, v17, v159
  v_cvt_pk_bf16_f32 v156, v156, v157
  v_cvt_pk_bf16_f32 v157, v158, v159
  ds_write_b64 v4, v[156:157] offset:8192
  s_waitcnt lgkmcnt(0)
  s_barrier
  ds_read_b64_tr_b16 v[60:61], v14 offset:49152
  ds_read_b64_tr_b16 v[62:63], v14 offset:53248
  ds_read_b64_tr_b16 v[64:65], v15 offset:49152
  ds_read_b64_tr_b16 v[66:67], v15 offset:53248
  ds_read_b64_tr_b16 v[68:69], v14 offset:57344
  ds_read_b64_tr_b16 v[70:71], v14 offset:61440
  ds_read_b64_tr_b16 v[72:73], v15 offset:57344
  ds_read_b64_tr_b16 v[74:75], v15 offset:61440
  v_xor_b32 v14, 0x10000, v14
  v_xor_b32 v15, 0x10000, v15
  ds_read_b128 v[28:31], v5 offset:0
  ds_read_b128 v[32:35], v5 offset:1024
  s_waitcnt lgkmcnt(8)
  v_mfma_f32_16x16x32_bf16 v[20:23], v[60:63], v[36:39], v[20:23]
  s_waitcnt lgkmcnt(6)
  v_mfma_f32_16x16x32_bf16 v[24:27], v[64:67], v[36:39], v[24:27]
  s_waitcnt lgkmcnt(4)
  v_mfma_f32_16x16x32_bf16 v[20:23], v[68:71], v[40:43], v[20:23]
  s_waitcnt lgkmcnt(2)
  v_mfma_f32_16x16x32_bf16 v[24:27], v[72:75], v[40:43], v[24:27]
  v_sub_f32 v160, v160, v16
  v_sub_f32 v161, v161, v16
  v_sub_f32 v162, v162, v16
  v_sub_f32 v163, v163, v16
  v_mul_f32 v160, s31, v160
  v_mul_f32 v161, s31, v161
  v_mul_f32 v162, s31, v162
  v_mul_f32 v163, s31, v163
  v_exp_f32 v160, v160
  v_exp_f32 v161, v161
  v_exp_f32 v162, v162
  v_exp_f32 v163, v163
  v_add_f32 v17, v17, v160
  v_add_f32 v17, v17, v161
  v_add_f32 v17, v17, v162
  v_add_f32 v17, v17, v163
  v_cvt_pk_bf16_f32 v160, v160, v161
  v_cvt_pk_bf16_f32 v161, v162, v163
  ds_write_b64 v4, v[160:161] offset:10240
  s_waitcnt lgkmcnt(0)
  s_barrier
  ds_read_b64_tr_b16 v[44:45], v14 offset:0
  ds_read_b64_tr_b16 v[46:47], v14 offset:4096
  ds_read_b64_tr_b16 v[48:49], v15 offset:0
  ds_read_b64_tr_b16 v[50:51], v15 offset:4096
  ds_read_b64_tr_b16 v[52:53], v14 offset:8192
  ds_read_b64_tr_b16 v[54:55], v14 offset:12288
  ds_read_b64_tr_b16 v[56:57], v15 offset:8192
  ds_read_b64_tr_b16 v[58:59], v15 offset:12288
  ds_read_b128 v[36:39], v5 offset:2048
  ds_read_b128 v[40:43], v5 offset:3072
  s_waitcnt lgkmcnt(8)
  v_mfma_f32_16x16x32_bf16 v[20:23], v[44:47], v[28:31], v[20:23]
  s_waitcnt lgkmcnt(6)
  v_mfma_f32_16x16x32_bf16 v[24:27], v[48:51], v[28:31], v[24:27]
  s_waitcnt lgkmcnt(4)
  v_mfma_f32_16x16x32_bf16 v[20:23], v[52:55], v[32:35], v[20:23]
  s_waitcnt lgkmcnt(2)
  v_mfma_f32_16x16x32_bf16 v[24:27], v[56:59], v[32:35], v[24:27]
  v_sub_f32 v164, v164, v16
  v_sub_f32 v165, v165, v16
  v_sub_f32 v166, v166, v16
  v_sub_f32 v167, v167, v16
  v_mul_f32 v164, s31, v164
  v_mul_f32 v165, s31, v165
  v_mul_f32 v166, s31, v166
  v_mul_f32 v167, s31, v167
  v_exp_f32 v164, v164
  v_exp_f32 v165, v165
  v_exp_f32 v166, v166
  v_exp_f32 v167, v167
  v_add_f32 v17, v17, v164
  v_add_f32 v17, v17, v165
  v_add_f32 v17, v17, v166
  v_add_f32 v17, v17, v167
  v_cvt_pk_bf16_f32 v164, v164, v165
  v_cvt_pk_bf16_f32 v165, v166, v167
  ds_write_b64 v4, v[164:165] offset:12288
  s_waitcnt lgkmcnt(0)
  s_barrier
  ds_read_b64_tr_b16 v[60:61], v14 offset:16384
  ds_read_b64_tr_b16 v[62:63], v14 offset:20480
  ds_read_b64_tr_b16 v[64:65], v15 offset:16384
  ds_read_b64_tr_b16 v[66:67], v15 offset:20480
  ds_read_b64_tr_b16 v[68:69], v14 offset:24576
  ds_read_b64_tr_b16 v[70:71], v14 offset:28672
  ds_read_b64_tr_b16 v[72:73], v15 offset:24576
  ds_read_b64_tr_b16 v[74:75], v15 offset:28672
  ds_read_b128 v[28:31], v5 offset:4096
  ds_read_b128 v[32:35], v5 offset:5120
  s_waitcnt lgkmcnt(8)
  v_mfma_f32_16x16x32_bf16 v[20:23], v[60:63], v[36:39], v[20:23]
  s_waitcnt lgkmcnt(6)
  v_mfma_f32_16x16x32_bf16 v[24:27], v[64:67], v[36:39], v[24:27]
  s_waitcnt lgkmcnt(4)
  v_mfma_f32_16x16x32_bf16 v[20:23], v[68:71], v[40:43], v[20:23]
  s_waitcnt lgkmcnt(2)
  v_mfma_f32_16x16x32_bf16 v[24:27], v[72:75], v[40:43], v[24:27]
  v_sub_f32 v168, v168, v16
  v_sub_f32 v169, v169, v16
  v_sub_f32 v170, v170, v16
  v_sub_f32 v171, v171, v16
  v_mul_f32 v168, s31, v168
  v_mul_f32 v169, s31, v169
  v_mul_f32 v170, s31, v170
  v_mul_f32 v171, s31, v171
  v_exp_f32 v168, v168
  v_exp_f32 v169, v169
  v_exp_f32 v170, v170
  v_exp_f32 v171, v171
  v_add_f32 v17, v17, v168
  v_add_f32 v17, v17, v169
  v_add_f32 v17, v17, v170
  v_add_f32 v17, v17, v171
  v_cvt_pk_bf16_f32 v168, v168, v169
  v_cvt_pk_bf16_f32 v169, v170, v171
  ds_write_b64 v4, v[168:169] offset:14336
  s_waitcnt lgkmcnt(0)
  s_barrier
  ds_read_b64_tr_b16 v[44:45], v14 offset:32768
  ds_read_b64_tr_b16 v[46:47], v14 offset:36864
  ds_read_b64_tr_b16 v[48:49], v15 offset:32768
  ds_read_b64_tr_b16 v[50:51], v15 offset:36864
  ds_read_b64_tr_b16 v[52:53], v14 offset:40960
  ds_read_b64_tr_b16 v[54:55], v14 offset:45056
  ds_read_b64_tr_b16 v[56:57], v15 offset:40960
  ds_read_b64_tr_b16 v[58:59], v15 offset:45056
  ds_read_b128 v[36:39], v5 offset:6144
  ds_read_b128 v[40:43], v5 offset:7168
  s_waitcnt lgkmcnt(8)
  v_mfma_f32_16x16x32_bf16 v[20:23], v[44:47], v[28:31], v[20:23]
  s_waitcnt lgkmcnt(6)
  v_mfma_f32_16x16x32_bf16 v[24:27], v[48:51], v[28:31], v[24:27]
  s_waitcnt lgkmcnt(4)
  v_mfma_f32_16x16x32_bf16 v[20:23], v[52:55], v[32:35], v[20:23]
  s_waitcnt lgkmcnt(2)
  v_mfma_f32_16x16x32_bf16 v[24:27], v[56:59], v[32:35], v[24:27]
  v_sub_f32 v172, v172, v16
  v_sub_f32 v173, v173, v16
  v_sub_f32 v174, v174, v16
  v_sub_f32 v175, v175, v16
  v_mul_f32 v172, s31, v172
  v_mul_f32 v173, s31, v173
  v_mul_f32 v174, s31, v174
  v_mul_f32 v175, s31, v175
  v_exp_f32 v172, v172
  v_exp_f32 v173, v173
  v_exp_f32 v174, v174
  v_exp_f32 v175, v175
  v_add_f32 v17, v17, v172
  v_add_f32 v17, v17, v173
  v_add_f32 v17, v17, v174
  v_add_f32 v17, v17, v175
  v_cvt_pk_bf16_f32 v172, v172, v173
  v_cvt_pk_bf16_f32 v173, v174, v175
  ds_write_b64 v4, v[172:173] offset:0
  s_waitcnt lgkmcnt(0)
  s_barrier
  ds_read_b64_tr_b16 v[60:61], v14 offset:49152
  ds_read_b64_tr_b16 v[62:63], v14 offset:53248
  ds_read_b64_tr_b16 v[64:65], v15 offset:49152
  ds_read_b64_tr_b16 v[66:67], v15 offset:53248
  ds_read_b64_tr_b16 v[68:69], v14 offset:57344
  ds_read_b64_tr_b16 v[70:71], v14 offset:61440
  ds_read_b64_tr_b16 v[72:73], v15 offset:57344
  ds_read_b64_tr_b16 v[74:75], v15 offset:61440
  v_xor_b32 v14, 0x10000, v14
  v_xor_b32 v15, 0x10000, v15
  ds_read_b128 v[28:31], v5 offset:8192
  ds_read_b128 v[32:35], v5 offset:9216
  s_waitcnt lgkmcnt(8)
  v_mfma_f32_16x16x32_bf16 v[20:23], v[60:63], v[36:39], v[20:23]
  s_waitcnt lgkmcnt(6)
  v_mfma_f32_16x16x32_bf16 v[24:27], v[64:67], v[36:39], v[24:27]
  s_waitcnt lgkmcnt(4)
  v_mfma_f32_16x16x32_bf16 v[20:23], v[68:71], v[40:43], v[20:23]
  s_waitcnt lgkmcnt(2)
  v_mfma_f32_16x16x32_bf16 v[24:27], v[72:75], v[40:43], v[24:27]
  v_sub_f32 v176, v176, v16
  v_sub_f32 v177, v177, v16
  v_sub_f32 v178, v178, v16
  v_sub_f32 v179, v179, v16
  v_mul_f32 v176, s31, v176
  v_mul_f32 v177, s31, v177
  v_mul_f32 v178, s31, v178
  v_mul_f32 v179, s31, v179
  v_exp_f32 v176, v176
  v_exp_f32 v177, v177
  v_exp_f32 v178, v178
  v_exp_f32 v179, v179
  v_add_f32 v17, v17, v176
  v_add_f32 v17, v17, v177
  v_add_f32 v17, v17, v178
  v_add_f32 v17, v17, v179
  v_cvt_pk_bf16_f32 v176, v176, v177
  v_cvt_pk_bf16_f32 v177, v178, v179
  ds_write_b64 v4, v[176:177] offset:2048
  s_waitcnt lgkmcnt(0)
  s_barrier
  ds_read_b64_tr_b16 v[44:45], v14 offset:0
  ds_read_b64_tr_b16 v[46:47], v14 offset:4096
  ds_read_b64_tr_b16 v[48:49], v15 offset:0
  ds_read_b64_tr_b16 v[50:51], v15 offset:4096
  ds_read_b64_tr_b16 v[52:53], v14 offset:8192
  ds_read_b64_tr_b16 v[54:55], v14 offset:12288
  ds_read_b64_tr_b16 v[56:57], v15 offset:8192
  ds_read_b64_tr_b16 v[58:59], v15 offset:12288
  ds_read_b128 v[36:39], v5 offset:10240
  ds_read_b128 v[40:43], v5 offset:11264
  s_waitcnt lgkmcnt(8)
  v_mfma_f32_16x16x32_bf16 v[20:23], v[44:47], v[28:31], v[20:23]
  s_waitcnt lgkmcnt(6)
  v_mfma_f32_16x16x32_bf16 v[24:27], v[48:51], v[28:31], v[24:27]
  s_waitcnt lgkmcnt(4)
  v_mfma_f32_16x16x32_bf16 v[20:23], v[52:55], v[32:35], v[20:23]
  s_waitcnt lgkmcnt(2)
  v_mfma_f32_16x16x32_bf16 v[24:27], v[56:59], v[32:35], v[24:27]
  v_sub_f32 v180, v180, v16
  v_sub_f32 v181, v181, v16
  v_sub_f32 v182, v182, v16
  v_sub_f32 v183, v183, v16
  v_mul_f32 v180, s31, v180
  v_mul_f32 v181, s31, v181
  v_mul_f32 v182, s31, v182
  v_mul_f32 v183, s31, v183
  v_exp_f32 v180, v180
  v_exp_f32 v181, v181
  v_exp_f32 v182, v182
  v_exp_f32 v183, v183
  v_add_f32 v17, v17, v180
  v_add_f32 v17, v17, v181
  v_add_f32 v17, v17, v182
  v_add_f32 v17, v17, v183
  v_cvt_pk_bf16_f32 v180, v180, v181
  v_cvt_pk_bf16_f32 v181, v182, v183
  ds_write_b64 v4, v[180:181] offset:4096
  s_waitcnt lgkmcnt(0)
  s_barrier
  ds_read_b64_tr_b16 v[60:61], v14 offset:16384
  ds_read_b64_tr_b16 v[62:63], v14 offset:20480
  ds_read_b64_tr_b16 v[64:65], v15 offset:16384
  ds_read_b64_tr_b16 v[66:67], v15 offset:20480
  ds_read_b64_tr_b16 v[68:69], v14 offset:24576
  ds_read_b64_tr_b16 v[70:71], v14 offset:28672
  ds_read_b64_tr_b16 v[72:73], v15 offset:24576
  ds_read_b64_tr_b16 v[74:75], v15 offset:28672
  ds_read_b128 v[28:31], v5 offset:12288
  ds_read_b128 v[32:35], v5 offset:13312
  s_waitcnt lgkmcnt(8)
  v_mfma_f32_16x16x32_bf16 v[20:23], v[60:63], v[36:39], v[20:23]
  s_waitcnt lgkmcnt(6)
  v_mfma_f32_16x16x32_bf16 v[24:27], v[64:67], v[36:39], v[24:27]
  s_waitcnt lgkmcnt(4)
  v_mfma_f32_16x16x32_bf16 v[20:23], v[68:71], v[40:43], v[20:23]
  s_waitcnt lgkmcnt(2)
  v_mfma_f32_16x16x32_bf16 v[24:27], v[72:75], v[40:43], v[24:27]
  v_sub_f32 v184, v184, v16
  v_sub_f32 v185, v185, v16
  v_sub_f32 v186, v186, v16
  v_sub_f32 v187, v187, v16
  v_mul_f32 v184, s31, v184
  v_mul_f32 v185, s31, v185
  v_mul_f32 v186, s31, v186
  v_mul_f32 v187, s31, v187
  v_exp_f32 v184, v184
  v_exp_f32 v185, v185
  v_exp_f32 v186, v186
  v_exp_f32 v187, v187
  v_add_f32 v17, v17, v184
  v_add_f32 v17, v17, v185
  v_add_f32 v17, v17, v186
  v_add_f32 v17, v17, v187
  v_cvt_pk_bf16_f32 v184, v184, v185
  v_cvt_pk_bf16_f32 v185, v186, v187
  ds_write_b64 v4, v[184:185] offset:6144
  s_waitcnt lgkmcnt(0)
  s_barrier
  ds_read_b64_tr_b16 v[44:45], v14 offset:32768
  ds_read_b64_tr_b16 v[46:47], v14 offset:36864
  ds_read_b64_tr_b16 v[48:49], v15 offset:32768
  ds_read_b64_tr_b16 v[50:51], v15 offset:36864
  ds_read_b64_tr_b16 v[52:53], v14 offset:40960
  ds_read_b64_tr_b16 v[54:55], v14 offset:45056
  ds_read_b64_tr_b16 v[56:57], v15 offset:40960
  ds_read_b64_tr_b16 v[58:59], v15 offset:45056
  ds_read_b128 v[36:39], v5 offset:14336
  ds_read_b128 v[40:43], v5 offset:15360
  s_waitcnt lgkmcnt(8)
  v_mfma_f32_16x16x32_bf16 v[20:23], v[44:47], v[28:31], v[20:23]
  s_waitcnt lgkmcnt(6)
  v_mfma_f32_16x16x32_bf16 v[24:27], v[48:51], v[28:31], v[24:27]
  s_waitcnt lgkmcnt(4)
  v_mfma_f32_16x16x32_bf16 v[20:23], v[52:55], v[32:35], v[20:23]
  s_waitcnt lgkmcnt(2)
  v_mfma_f32_16x16x32_bf16 v[24:27], v[56:59], v[32:35], v[24:27]
  v_sub_f32 v188, v188, v16
  v_sub_f32 v189, v189, v16
  v_sub_f32 v190, v190, v16
  v_sub_f32 v191, v191, v16
  v_mul_f32 v188, s31, v188
  v_mul_f32 v189, s31, v189
  v_mul_f32 v190, s31, v190
  v_mul_f32 v191, s31, v191
  v_exp_f32 v188, v188
  v_exp_f32 v189, v189
  v_exp_f32 v190, v190
  v_exp_f32 v191, v191
  v_add_f32 v17, v17, v188
  v_add_f32 v17, v17, v189
  v_add_f32 v17, v17, v190
  v_add_f32 v17, v17, v191
  v_cvt_pk_bf16_f32 v188, v188, v189
  v_cvt_pk_bf16_f32 v189, v190, v191
  ds_write_b64 v4, v[188:189] offset:8192
  s_waitcnt lgkmcnt(0)
  s_barrier
  ds_read_b64_tr_b16 v[60:61], v14 offset:49152
  ds_read_b64_tr_b16 v[62:63], v14 offset:53248
  ds_read_b64_tr_b16 v[64:65], v15 offset:49152
  ds_read_b64_tr_b16 v[66:67], v15 offset:53248
  ds_read_b64_tr_b16 v[68:69], v14 offset:57344
  ds_read_b64_tr_b16 v[70:71], v14 offset:61440
  ds_read_b64_tr_b16 v[72:73], v15 offset:57344
  ds_read_b64_tr_b16 v[74:75], v15 offset:61440
  v_xor_b32 v14, 0x10000, v14
  v_xor_b32 v15, 0x10000, v15
  ds_read_b128 v[28:31], v5 offset:0
  ds_read_b128 v[32:35], v5 offset:1024
  s_waitcnt lgkmcnt(8)
  v_mfma_f32_16x16x32_bf16 v[20:23], v[60:63], v[36:39], v[20:23]
  s_waitcnt lgkmcnt(6)
  v_mfma_f32_16x16x32_bf16 v[24:27], v[64:67], v[36:39], v[24:27]
  s_waitcnt lgkmcnt(4)
  v_mfma_f32_16x16x32_bf16 v[20:23], v[68:71], v[40:43], v[20:23]
  s_waitcnt lgkmcnt(2)
  v_mfma_f32_16x16x32_bf16 v[24:27], v[72:75], v[40:43], v[24:27]
  v_sub_f32 v192, v192, v16
  v_sub_f32 v193, v193, v16
  v_sub_f32 v194, v194, v16
  v_sub_f32 v195, v195, v16
  v_mul_f32 v192, s31, v192
  v_mul_f32 v193, s31, v193
  v_mul_f32 v194, s31, v194
  v_mul_f32 v195, s31, v195
  v_exp_f32 v192, v192
  v_exp_f32 v193, v193
  v_exp_f32 v194, v194
  v_exp_f32 v195, v195
  v_add_f32 v17, v17, v192
  v_add_f32 v17, v17, v193
  v_add_f32 v17, v17, v194
  v_add_f32 v17, v17, v195
  s_waitcnt lgkmcnt(0)
  s_barrier
  ds_read_b64_tr_b16 v[44:45], v14 offset:0
  ds_read_b64_tr_b16 v[46:47], v14 offset:4096
  ds_read_b64_tr_b16 v[48:49], v15 offset:0
  ds_read_b64_tr_b16 v[50:51], v15 offset:4096
  ds_read_b64_tr_b16 v[52:53], v14 offset:8192
  ds_read_b64_tr_b16 v[54:55], v14 offset:12288
  ds_read_b64_tr_b16 v[56:57], v15 offset:8192
  ds_read_b64_tr_b16 v[58:59], v15 offset:12288
  ds_read_b128 v[36:39], v5 offset:2048
  ds_read_b128 v[40:43], v5 offset:3072
  s_waitcnt lgkmcnt(8)
  v_mfma_f32_16x16x32_bf16 v[20:23], v[44:47], v[28:31], v[20:23]
  s_waitcnt lgkmcnt(6)
  v_mfma_f32_16x16x32_bf16 v[24:27], v[48:51], v[28:31], v[24:27]
  s_waitcnt lgkmcnt(4)
  v_mfma_f32_16x16x32_bf16 v[20:23], v[52:55], v[32:35], v[20:23]
  s_waitcnt lgkmcnt(2)
  v_mfma_f32_16x16x32_bf16 v[24:27], v[56:59], v[32:35], v[24:27]
  v_sub_f32 v196, v196, v16
  v_sub_f32 v197, v197, v16
  v_sub_f32 v198, v198, v16
  v_sub_f32 v199, v199, v16
  v_mul_f32 v196, s31, v196
  v_mul_f32 v197, s31, v197
  v_mul_f32 v198, s31, v198
  v_mul_f32 v199, s31, v199
  v_exp_f32 v196, v196
  v_exp_f32 v197, v197
  v_exp_f32 v198, v198
  v_exp_f32 v199, v199
  v_add_f32 v17, v17, v196
  v_add_f32 v17, v17, v197
  v_add_f32 v17, v17, v198
  v_add_f32 v17, v17, v199
  s_waitcnt lgkmcnt(0)
  s_barrier
  ds_read_b64_tr_b16 v[60:61], v14 offset:16384
  ds_read_b64_tr_b16 v[62:63], v14 offset:20480
  ds_read_b64_tr_b16 v[64:65], v15 offset:16384
  ds_read_b64_tr_b16 v[66:67], v15 offset:20480
  ds_read_b64_tr_b16 v[68:69], v14 offset:24576
  ds_read_b64_tr_b16 v[70:71], v14 offset:28672
  ds_read_b64_tr_b16 v[72:73], v15 offset:24576
  ds_read_b64_tr_b16 v[74:75], v15 offset:28672
  ds_read_b128 v[28:31], v5 offset:4096
  ds_read_b128 v[32:35], v5 offset:5120
  s_waitcnt lgkmcnt(8)
  v_mfma_f32_16x16x32_bf16 v[20:23], v[60:63], v[36:39], v[20:23]
  s_waitcnt lgkmcnt(6)
  v_mfma_f32_16x16x32_bf16 v[24:27], v[64:67], v[36:39], v[24:27]
  s_waitcnt lgkmcnt(4)
  v_mfma_f32_16x16x32_bf16 v[20:23], v[68:71], v[40:43], v[20:23]
  s_waitcnt lgkmcnt(2)
  v_mfma_f32_16x16x32_bf16 v[24:27], v[72:75], v[40:43], v[24:27]
  v_sub_f32 v200, v200, v16
  v_sub_f32 v201, v201, v16
  v_sub_f32 v202, v202, v16
  v_sub_f32 v203, v203, v16
  v_mul_f32 v200, s31, v200
  v_mul_f32 v201, s31, v201
  v_mul_f32 v202, s31, v202
  v_mul_f32 v203, s31, v203
  v_exp_f32 v200, v200
  v_exp_f32 v201, v201
  v_exp_f32 v202, v202
  v_exp_f32 v203, v203
  v_add_f32 v17, v17, v200
  v_add_f32 v17, v17, v201
  v_add_f32 v17, v17, v202
  v_add_f32 v17, v17, v203
  ds_write_b32 v6, v17 offset:17408
  s_waitcnt lgkmcnt(0)
  s_barrier
  ds_read_b64_tr_b16 v[44:45], v14 offset:32768
  ds_read_b64_tr_b16 v[46:47], v14 offset:36864
  ds_read_b64_tr_b16 v[48:49], v15 offset:32768
  ds_read_b64_tr_b16 v[50:51], v15 offset:36864
  ds_read_b64_tr_b16 v[52:53], v14 offset:40960
  ds_read_b64_tr_b16 v[54:55], v14 offset:45056
  ds_read_b64_tr_b16 v[56:57], v15 offset:40960
  ds_read_b64_tr_b16 v[58:59], v15 offset:45056
  ds_read_b128 v[36:39], v5 offset:6144
  ds_read_b128 v[40:43], v5 offset:7168
  ds_read_b128 v[76:79], v5 offset:17408
  s_waitcnt lgkmcnt(9)
  v_mfma_f32_16x16x32_bf16 v[20:23], v[44:47], v[28:31], v[20:23]
  s_waitcnt lgkmcnt(7)
  v_mfma_f32_16x16x32_bf16 v[24:27], v[48:51], v[28:31], v[24:27]
  s_waitcnt lgkmcnt(5)
  v_mfma_f32_16x16x32_bf16 v[20:23], v[52:55], v[32:35], v[20:23]
  s_waitcnt lgkmcnt(3)
  v_mfma_f32_16x16x32_bf16 v[24:27], v[56:59], v[32:35], v[24:27]
  s_waitcnt lgkmcnt(0)
  v_add_f32 v17, v76, v77
  v_add_f32 v17, v17, v78
  v_add_f32 v17, v17, v79
  v_mov_b32 v1, v17
  s_nop 1
  v_permlane32_swap_b32 v17, v1
  s_nop 1
  v_add_f32 v17, v17, v1
  v_mov_b32 v1, v17
  s_nop 1
  v_permlane16_swap_b32 v17, v1
  s_nop 1
  v_add_f32 v17, v17, v1
  v_rcp_f32 v17, v17
  s_waitcnt lgkmcnt(0)
  s_barrier
  ds_read_b64_tr_b16 v[60:61], v14 offset:49152
  ds_read_b64_tr_b16 v[62:63], v14 offset:53248
  ds_read_b64_tr_b16 v[64:65], v15 offset:49152
  ds_read_b64_tr_b16 v[66:67], v15 offset:53248
  ds_read_b64_tr_b16 v[68:69], v14 offset:57344
  ds_read_b64_tr_b16 v[70:71], v14 offset:61440
  ds_read_b64_tr_b16 v[72:73], v15 offset:57344
  ds_read_b64_tr_b16 v[74:75], v15 offset:61440
  v_xor_b32 v14, 0x10000, v14
  v_xor_b32 v15, 0x10000, v15
  ds_read_b128 v[28:31], v5 offset:8192
  ds_read_b128 v[32:35], v5 offset:9216
  s_waitcnt lgkmcnt(8)
  v_mfma_f32_16x16x32_bf16 v[20:23], v[60:63], v[36:39], v[20:23]
  s_waitcnt lgkmcnt(6)
  v_mfma_f32_16x16x32_bf16 v[24:27], v[64:67], v[36:39], v[24:27]
  s_waitcnt lgkmcnt(4)
  v_mfma_f32_16x16x32_bf16 v[20:23], v[68:71], v[40:43], v[20:23]
  s_waitcnt lgkmcnt(2)
  v_mfma_f32_16x16x32_bf16 v[24:27], v[72:75], v[40:43], v[24:27]
  v_mul_f32 v192, v17, v192
  v_mul_f32 v193, v17, v193
  v_mul_f32 v194, v17, v194
  v_mul_f32 v195, v17, v195
  v_cvt_pk_bf16_f32 v192, v192, v193
  v_cvt_pk_bf16_f32 v193, v194, v195
  ds_write_b64 v4, v[192:193] offset:10240
  v_mul_f32 v196, v17, v196
  v_mul_f32 v197, v17, v197
  v_mul_f32 v198, v17, v198
  v_mul_f32 v199, v17, v199
  v_cvt_pk_bf16_f32 v196, v196, v197
  v_cvt_pk_bf16_f32 v197, v198, v199
  ds_write_b64 v4, v[196:197] offset:12288
  v_mul_f32 v200, v17, v200
  v_mul_f32 v201, v17, v201
  v_mul_f32 v202, v17, v202
  v_mul_f32 v203, v17, v203
  v_cvt_pk_bf16_f32 v200, v200, v201
  v_cvt_pk_bf16_f32 v201, v202, v203
  ds_write_b64 v4, v[200:201] offset:14336
  s_waitcnt lgkmcnt(0)
  s_barrier
  ds_read_b64_tr_b16 v[44:45], v14 offset:0
  ds_read_b64_tr_b16 v[46:47], v14 offset:4096
  ds_read_b64_tr_b16 v[48:49], v15 offset:0
  ds_read_b64_tr_b16 v[50:51], v15 offset:4096
  ds_read_b64_tr_b16 v[52:53], v14 offset:8192
  ds_read_b64_tr_b16 v[54:55], v14 offset:12288
  ds_read_b64_tr_b16 v[56:57], v15 offset:8192
  ds_read_b64_tr_b16 v[58:59], v15 offset:12288
  ds_read_b128 v[36:39], v5 offset:10240
  ds_read_b128 v[40:43], v5 offset:11264
  s_waitcnt lgkmcnt(8)
  v_mfma_f32_16x16x32_bf16 v[20:23], v[44:47], v[28:31], v[20:23]
  s_waitcnt lgkmcnt(6)
  v_mfma_f32_16x16x32_bf16 v[24:27], v[48:51], v[28:31], v[24:27]
  s_waitcnt lgkmcnt(4)
  v_mfma_f32_16x16x32_bf16 v[20:23], v[52:55], v[32:35], v[20:23]
  s_waitcnt lgkmcnt(2)
  v_mfma_f32_16x16x32_bf16 v[24:27], v[56:59], v[32:35], v[24:27]
  s_nop 6
  v_mul_f32 v20, v17, v20
  v_mul_f32 v21, v17, v21
  v_mul_f32 v22, v17, v22
  v_mul_f32 v23, v17, v23
  v_mul_f32 v24, v17, v24
  v_mul_f32 v25, v17, v25
  v_mul_f32 v26, v17, v26
  v_mul_f32 v27, v17, v27
  s_waitcnt lgkmcnt(0)
  s_barrier
  ds_read_b64_tr_b16 v[60:61], v14 offset:16384
  ds_read_b64_tr_b16 v[62:63], v14 offset:20480
  ds_read_b64_tr_b16 v[64:65], v15 offset:16384
  ds_read_b64_tr_b16 v[66:67], v15 offset:20480
  ds_read_b64_tr_b16 v[68:69], v14 offset:24576
  ds_read_b64_tr_b16 v[70:71], v14 offset:28672
  ds_read_b64_tr_b16 v[72:73], v15 offset:24576
  ds_read_b64_tr_b16 v[74:75], v15 offset:28672
  ds_read_b128 v[28:31], v5 offset:12288
  ds_read_b128 v[32:35], v5 offset:13312
  s_waitcnt lgkmcnt(8)
  v_mfma_f32_16x16x32_bf16 v[20:23], v[60:63], v[36:39], v[20:23]
  s_waitcnt lgkmcnt(6)
  v_mfma_f32_16x16x32_bf16 v[24:27], v[64:67], v[36:39], v[24:27]
  s_waitcnt lgkmcnt(4)
  v_mfma_f32_16x16x32_bf16 v[20:23], v[68:71], v[40:43], v[20:23]
  s_waitcnt lgkmcnt(2)
  v_mfma_f32_16x16x32_bf16 v[24:27], v[72:75], v[40:43], v[24:27]
  s_waitcnt lgkmcnt(0)
  s_barrier
  ds_read_b64_tr_b16 v[44:45], v14 offset:32768
  ds_read_b64_tr_b16 v[46:47], v14 offset:36864
  ds_read_b64_tr_b16 v[48:49], v15 offset:32768
  ds_read_b64_tr_b16 v[50:51], v15 offset:36864
  ds_read_b64_tr_b16 v[52:53], v14 offset:40960
  ds_read_b64_tr_b16 v[54:55], v14 offset:45056
  ds_read_b64_tr_b16 v[56:57], v15 offset:40960
  ds_read_b64_tr_b16 v[58:59], v15 offset:45056
  ds_read_b128 v[36:39], v5 offset:14336
  ds_read_b128 v[40:43], v5 offset:15360
  s_waitcnt lgkmcnt(8)
  v_mfma_f32_16x16x32_bf16 v[20:23], v[44:47], v[28:31], v[20:23]
  s_waitcnt lgkmcnt(6)
  v_mfma_f32_16x16x32_bf16 v[24:27], v[48:51], v[28:31], v[24:27]
  s_waitcnt lgkmcnt(4)
  v_mfma_f32_16x16x32_bf16 v[20:23], v[52:55], v[32:35], v[20:23]
  s_waitcnt lgkmcnt(2)
  v_mfma_f32_16x16x32_bf16 v[24:27], v[56:59], v[32:35], v[24:27]
  s_waitcnt lgkmcnt(0)
  s_barrier
  ds_read_b64_tr_b16 v[60:61], v14 offset:49152
  ds_read_b64_tr_b16 v[62:63], v14 offset:53248
  ds_read_b64_tr_b16 v[64:65], v15 offset:49152
  ds_read_b64_tr_b16 v[66:67], v15 offset:53248
  s_waitcnt lgkmcnt(2)
  v_mfma_f32_16x16x32_bf16 v[20:23], v[60:63], v[36:39], v[20:23]
  s_waitcnt lgkmcnt(0)
  v_mfma_f32_16x16x32_bf16 v[24:27], v[64:67], v[36:39], v[24:27]
  s_barrier
  ds_read_b64_tr_b16 v[68:69], v14 offset:57344
  ds_read_b64_tr_b16 v[70:71], v14 offset:61440
  ds_read_b64_tr_b16 v[72:73], v15 offset:57344
  ds_read_b64_tr_b16 v[74:75], v15 offset:61440
  s_waitcnt lgkmcnt(2)
  v_mfma_f32_16x16x32_bf16 v[20:23], v[68:71], v[40:43], v[20:23]
  s_waitcnt lgkmcnt(0)
  v_mfma_f32_16x16x32_bf16 v[24:27], v[72:75], v[40:43], v[24:27]
  s_nop 6
  v_cvt_pk_bf16_f32 v20, v20, v21
  v_cvt_pk_bf16_f32 v21, v22, v23
  v_cvt_pk_bf16_f32 v22, v24, v25
  v_cvt_pk_bf16_f32 v23, v26, v27
  s_nop 0
  v_permlane16_swap_b32 v20, v22
  v_permlane16_swap_b32 v21, v23
  ds_bpermute_b32 v20, v18, v20
  ds_bpermute_b32 v21, v18, v21
  ds_bpermute_b32 v22, v18, v22
  ds_bpermute_b32 v23, v18, v23
  s_waitcnt lgkmcnt(0)
  buffer_store_dwordx4 v[20:23], v7, s[24:27], 0 offen
L_end:
  s_endpgm
.section .rodata,"a"
.p2align 6
.amdhsa_kernel standalone__mha_softmax__sampling_kernel
  .amdhsa_next_free_vgpr 208
  .amdhsa_next_free_sgpr 64
  .amdhsa_accum_offset 208
  .amdhsa_group_segment_fixed_size 0
  .amdhsa_kernarg_size 48
  .amdhsa_user_sgpr_count 2
  .amdhsa_user_sgpr_kernarg_segment_ptr 1
  .amdhsa_system_sgpr_workgroup_id_x 1
.end_amdhsa_kernel
```
